```python
import torch

def _softmax(x, axis=-1):
    return torch.softmax(x, dim=axis)
def _gelu(x):
    return torch.nn.functional.gelu(x, approximate="tanh")
def _silu(x):
    return torch.nn.functional.silu(x)
def _sigmoid(x):
    return torch.sigmoid(x)
def _layernorm(x, axis=-1, eps=1e-5):
    m = x.mean(dim=axis, keepdim=True)
    v = x.var(dim=axis, keepdim=True, unbiased=False)
    return (x - m) / torch.sqrt(v + eps)
def _scatter_add(tgt, idx, src, axis=0):
    return tgt.clone().index_add_(axis, idx, src)
def _segment_sum(src, seg, n):
    out = torch.zeros((n,) + src.shape[1:], dtype=src.dtype)
    return out.index_add_(0, seg, src)
def _pad(x, pw):
    flat = tuple(v for pair in reversed(pw) for v in pair)
    return torch.nn.functional.pad(x, flat)

kernel_name = 'parallel_sum__grouped_kv_mqa__dense_activation_squared_relu__prompt'

def setup_inputs():

    _w = (lambda a: (lambda t: t.to(torch.bfloat16) if t.is_floating_point() else t)(torch.as_tensor(a)))
    def _A_setup():
        B, S, D, H = 1, 2048, 512, 32
        Dh = D // H
        return {
            "x": _w((lambda *s: torch.randn(*s, dtype=torch.bfloat16) * 0.05)(B, S, D)),
            "wq": _w((lambda *s: torch.randn(*s, dtype=torch.bfloat16) * 0.2)(D, H * Dh)),
            "wk": _w((lambda *s: torch.randn(*s, dtype=torch.bfloat16) * 0.2)(D, Dh)),
            "wv": _w((lambda *s: torch.randn(*s, dtype=torch.bfloat16) * 0.1)(D, Dh)),
            "wo": _w((lambda *s: torch.randn(*s, dtype=torch.bfloat16) * 0.1)(H * Dh, D)),
        }
    _A_in = _A_setup()

    def _B_setup():
        B, S, D, F = 1, 2048, 512, 1376
        return {
            "x": _w((lambda *s: torch.randn(*s, dtype=torch.bfloat16) * 0.05)(B, S, D)),
            "w1": _w((lambda *s: torch.randn(*s, dtype=torch.bfloat16) * 0.05)(D, F)),
            "b1": _w((lambda *s: torch.randn(*s, dtype=torch.bfloat16) * 1.6)(F)),
            "w2": _w((lambda *s: torch.randn(*s, dtype=torch.bfloat16) * 0.05)(F, D)),
            "b2": _w((lambda *s: torch.randn(*s, dtype=torch.bfloat16) * 6.4)(D)),
        }
    _B_in = _B_setup()

    return {
        "A_x": _A_in["x"],
        "A_wq": _A_in["wq"],
        "A_wk": _A_in["wk"],
        "A_wv": _A_in["wv"],
        "A_wo": _A_in["wo"],
        "B_x": _B_in["x"],
        "B_w1": _B_in["w1"],
        "B_b1": _B_in["b1"],
        "B_w2": _B_in["w2"],
        "B_b2": _B_in["b2"],
    }

def reference(A_x, A_wq, A_wk, A_wv, A_wo, B_x, B_w1, B_b1, B_w2, B_b2):
    def _A_ref(x, wq, wk, wv, wo):
        B, S, D = x.shape
        H = 32
        Dh = D // H
        q = (lambda x, *d: x.permute(*d))((x @ wq).reshape(B, S, H, Dh), 0, 2, 1, 3)
        k = x @ wk
        v = x @ wv
        scores = torch.einsum("bhqd,bkd->bhqk", q, k) * (Dh ** -0.5)
        p = _softmax(scores, axis=-1)
        o = torch.einsum("bhqk,bkd->bhqd", p, v)
        return (lambda x, *d: x.permute(*d))(o, 0, 2, 1, 3).reshape(B, S, H * Dh) @ wo

    def _B_ref(x, w1, b1, w2, b2):
        h = torch.einsum("bsd,df->bsf", x, w1) + b1
        zero = torch.zeros_like(h)
        r = torch.where(h > zero, h, zero)
        h = r * r
        out = torch.einsum("bsf,fd->bsd", h, w2) + b2
        return out

    x = A_x
    xn = _layernorm(x, axis=-1)
    return x + _A_ref(xn, A_wq, A_wk, A_wv, A_wo) + _B_ref(xn, B_w1, B_b1, B_w2, B_b2)
```

```asm
; @launch grid=(256,1,1) block=(768,1,1) lds=163840
.amdgcn_target "amdgcn-amd-amdhsa--gfx950"
.text
.globl parallel_sum__grouped_kv_mqa__dense_activation_squared_relu__prompt_kernel
.p2align 8
.type parallel_sum__grouped_kv_mqa__dense_activation_squared_relu__prompt_kernel,@function
parallel_sum__grouped_kv_mqa__dense_activation_squared_relu__prompt_kernel:
    s_memrealtime s[34:35]
    s_load_dwordx16 s[8:23], s[0:1], 0
    s_load_dwordx8 s[24:31], s[0:1], 64
    s_load_dwordx2 s[32:33], s[0:1], 96
    s_cmp_ge_u32 s2, 256
    s_cbranch_scc1 L_end
    v_lshrrev_b32 v1, 6, v0
    s_and_b32 s4, s2, 7
    v_readfirstlane_b32 s3, v1
    s_lshl_b32 s4, s4, 2
    s_lshr_b32 s57, s2, 6
    s_add_u32 s4, s4, s57
    s_bfe_u32 s5, s2, 0x30003
    s_lshr_b32 s6, s5, 1
    s_and_b32 s7, s5, 1
    v_and_b32 v0, 63, v0
    s_cmp_lg_u32 s3, 10
    s_cbranch_scc1 L_nocp
    s_getpc_b64 s[48:49]
L_pc:
    v_lshlrev_b32 v2, 7, v0
    s_lshr_b32 s57, s2, 3
    s_lshl_b32 s57, s57, 10
    v_add_u32 v2, s57, v2
    v_min_u32 v2, L_fallback-L_pc, v2
    s_mov_b64 exec, 0xff
    global_load_dword v6, v2, s[48:49]
    s_mov_b64 exec, -1
L_nocp:
    s_cmp_ge_u32 s3, 8
    s_cbranch_scc1 L_gwave
    v_lshrrev_b32 v3, 5, v0
    v_and_b32 v4, 31, v0
    s_lshl_b32 s57, s3, 1
    v_add_u32 v3, s57, v3
    v_lshlrev_b32 v1, 10, v3
    v_lshl_add_u32 v5, v4, 4, v1
    s_lshl_b32 s58, s4, 16
    s_lshl_b32 s59, s6, 14
    s_add_u32 s60, s58, s59
    s_waitcnt lgkmcnt(0)
    s_mov_b32 s36, s8
    s_mov_b32 s37, s9
    s_mov_b32 s38, 2097152
    s_mov_b32 s39, 0x20000
    buffer_load_dwordx4 v[8:11], v5, s[36:39], s60 offen
    buffer_load_dwordx4 v[12:15], v5, s[36:39], s60 offen offset:512
    s_mov_b32 s40, s32
    s_mov_b32 s41, s33
    s_mov_b32 s42, 10485760
    s_mov_b32 s43, 0x20000
    v_mov_b64 v[136:137], 0
    v_mov_b64 v[138:139], 0
    v_mov_b32 v152, 152832
    v_lshlrev_b32 v158, 5, v4
    v_and_b32 v6, 15, v0
    v_cmp_eq_u32 vcc, 0, v6
    ds_write_b128 v152, v[136:139]
    ds_write_b128 v152, v[136:139] offset:16
    ds_write_b128 v152, v[136:139] offset:32
    ds_write_b128 v152, v[136:139] offset:48
    v_xor_b32 v4, v4, v3
    v_lshl_add_u32 v2, v4, 4, v1
    v_lshlrev_b32 v3, 2, v3
    v_add_u32 v3, 149504, v3
    v_mov_b32 v160, 0x3f803f80
    v_mov_b32 v161, 0x3f80
    v_mov_b32 v162, 0x3f800000
    v_cndmask_b32 v44, 0, v160, vcc
    v_cndmask_b32 v45, 0, v160, vcc
    v_mov_b64 v[46:47], v[44:45]
    v_mov_b64 v[52:53], v[44:45]
    v_mov_b64 v[54:55], v[44:45]
    v_mov_b64 v[60:61], v[44:45]
    v_mov_b64 v[62:63], v[44:45]
    v_mov_b64 v[68:69], v[44:45]
    v_mov_b64 v[70:71], v[44:45]
    v_mov_b64 v[76:77], v[44:45]
    v_mov_b64 v[78:79], v[44:45]
    v_mov_b64 v[84:85], v[44:45]
    v_mov_b64 v[86:87], v[44:45]
    v_mov_b64 v[92:93], v[44:45]
    v_mov_b64 v[94:95], v[44:45]
    v_mov_b64 v[100:101], v[44:45]
    v_mov_b64 v[102:103], v[44:45]
    v_lshlrev_b32 v156, 4, v0
    v_lshrrev_b32 v4, 4, v0
    v_lshlrev_b32 v159, 6, v4
    v_lshlrev_b32 v0, 2, v0
    s_mov_b32 s57, 0x3b000000
    s_setprio 2
    s_waitcnt lgkmcnt(0)
    s_barrier
    s_xor_b32 s60, s59, 16384
    s_add_u32 s60, s58, s60
    buffer_load_dwordx4 v[16:19], v5, s[36:39], s60 offen
    buffer_load_dwordx4 v[20:23], v5, s[36:39], s60 offen offset:512
    s_cmp_ge_u32 s3, 4
    s_cbranch_scc1 L_xh1
    s_xor_b32 s60, s59, 32768
    s_add_u32 s60, s58, s60
    buffer_load_dwordx4 v[24:27], v5, s[36:39], s60 offen
    buffer_load_dwordx4 v[28:31], v5, s[36:39], s60 offen offset:512
    s_xor_b32 s60, s59, 49152
    s_add_u32 s60, s58, s60
    buffer_load_dwordx4 v[32:35], v5, s[36:39], s60 offen
    buffer_load_dwordx4 v[36:39], v5, s[36:39], s60 offen offset:512
    s_waitcnt vmcnt(6)
    s_branch L_xh2
L_xh1:
    s_waitcnt vmcnt(2)
L_xh2:
    v_dot2_f32_bf16 v120, v8, v160, 0
    v_dot2_f32_bf16 v121, v9, v160, 0
    v_dot2_f32_bf16 v120, v10, v160, v120
    v_dot2_f32_bf16 v121, v11, v160, v121
    v_dot2_f32_bf16 v120, v12, v160, v120
    v_dot2_f32_bf16 v121, v13, v160, v121
    v_dot2_f32_bf16 v120, v14, v160, v120
    v_dot2_f32_bf16 v121, v15, v160, v121
    s_nop 2
    v_add_f32 v120, v120, v121
    s_nop 1
    v_add_f32_dpp v120, v120, v120 quad_perm:[1,0,3,2] row_mask:0xf bank_mask:0xf
    s_nop 1
    v_add_f32_dpp v120, v120, v120 quad_perm:[2,3,0,1] row_mask:0xf bank_mask:0xf
    s_nop 1
    v_add_f32_dpp v120, v120, v120 row_half_mirror row_mask:0xf bank_mask:0xf
    s_nop 1
    v_add_f32_dpp v120, v120, v120 row_mirror row_mask:0xf bank_mask:0xf
    v_mov_b32 v121, v120
    s_nop 1
    v_permlane16_swap_b32 v120, v121
    v_add_f32 v120, v120, v121
    v_mul_f32 v120, 0xbb000000, v120
    s_xor_b32 s60, s59, 0
    v_add_u32 v7, s60, v2
    v_dot2_f32_bf16 v104, v8, v161, v120
    v_dot2_f32_bf16 v105, v8, v162, v120
    v_dot2_f32_bf16 v106, v9, v161, v120
    v_dot2_f32_bf16 v107, v9, v162, v120
    v_dot2_f32_bf16 v108, v10, v161, v120
    v_dot2_f32_bf16 v109, v10, v162, v120
    v_dot2_f32_bf16 v110, v11, v161, v120
    v_dot2_f32_bf16 v111, v11, v162, v120
    v_dot2_f32_bf16 v112, v12, v161, v120
    v_dot2_f32_bf16 v113, v12, v162, v120
    v_dot2_f32_bf16 v114, v13, v161, v120
    v_dot2_f32_bf16 v115, v13, v162, v120
    v_dot2_f32_bf16 v116, v14, v161, v120
    v_dot2_f32_bf16 v117, v14, v162, v120
    v_dot2_f32_bf16 v118, v15, v161, v120
    v_dot2_f32_bf16 v119, v15, v162, v120
    v_cvt_pk_bf16_f32 v8, v104, v105
    v_pk_mul_f32 v[120:121], v[104:105], v[104:105]
    v_cvt_pk_bf16_f32 v9, v106, v107
    v_pk_fma_f32 v[120:121], v[106:107], v[106:107], v[120:121]
    v_cvt_pk_bf16_f32 v10, v108, v109
    v_pk_fma_f32 v[120:121], v[108:109], v[108:109], v[120:121]
    v_cvt_pk_bf16_f32 v11, v110, v111
    v_pk_fma_f32 v[120:121], v[110:111], v[110:111], v[120:121]
    ds_write_b128 v7, v[8:11]
    v_cvt_pk_bf16_f32 v12, v112, v113
    v_pk_fma_f32 v[120:121], v[112:113], v[112:113], v[120:121]
    v_cvt_pk_bf16_f32 v13, v114, v115
    v_pk_fma_f32 v[120:121], v[114:115], v[114:115], v[120:121]
    v_cvt_pk_bf16_f32 v14, v116, v117
    v_pk_fma_f32 v[120:121], v[116:117], v[116:117], v[120:121]
    v_cvt_pk_bf16_f32 v15, v118, v119
    v_pk_fma_f32 v[120:121], v[118:119], v[118:119], v[120:121]
    ds_write_b128 v7, v[12:15] offset:512
    v_add_f32 v120, v120, v121
    s_nop 1
    v_add_f32_dpp v120, v120, v120 quad_perm:[1,0,3,2] row_mask:0xf bank_mask:0xf
    s_nop 1
    v_add_f32_dpp v120, v120, v120 quad_perm:[2,3,0,1] row_mask:0xf bank_mask:0xf
    s_nop 1
    v_add_f32_dpp v120, v120, v120 row_half_mirror row_mask:0xf bank_mask:0xf
    s_nop 1
    v_add_f32_dpp v120, v120, v120 row_mirror row_mask:0xf bank_mask:0xf
    v_mov_b32 v121, v120
    s_nop 1
    v_permlane16_swap_b32 v120, v121
    v_add_f32 v120, v120, v121
    v_mov_b32 v7, 0x3727c5ac
    v_fma_f32 v120, v120, s57, v7
    v_rsq_f32 v120, v120
    s_xor_b32 s60, s59, 0
    s_lshr_b32 s60, s60, 8
    v_add_u32 v121, s60, v3
    ds_write_b32 v121, v120
    v_mov_b32 v7, 1
    s_mov_b64 exec, 1
    ds_add_u32 v152, v7 offset:28
    s_mov_b64 exec, -1
    s_cmp_lt_u32 s3, 4
    s_cbranch_scc1 L_xh3
    s_xor_b32 s60, s59, 32768
    s_add_u32 s60, s58, s60
    buffer_load_dwordx4 v[24:27], v5, s[36:39], s60 offen
    buffer_load_dwordx4 v[28:31], v5, s[36:39], s60 offen offset:512
    s_xor_b32 s60, s59, 49152
    s_add_u32 s60, s58, s60
    buffer_load_dwordx4 v[32:35], v5, s[36:39], s60 offen
    buffer_load_dwordx4 v[36:39], v5, s[36:39], s60 offen offset:512
L_xh3:
    s_setprio 1
    s_waitcnt vmcnt(0)
    v_dot2_f32_bf16 v122, v16, v160, 0
    v_dot2_f32_bf16 v124, v24, v160, 0
    v_dot2_f32_bf16 v120, v32, v160, 0
    v_dot2_f32_bf16 v123, v17, v160, 0
    v_dot2_f32_bf16 v125, v25, v160, 0
    v_dot2_f32_bf16 v121, v33, v160, 0
    v_dot2_f32_bf16 v122, v18, v160, v122
    v_dot2_f32_bf16 v124, v26, v160, v124
    v_dot2_f32_bf16 v120, v34, v160, v120
    v_dot2_f32_bf16 v123, v19, v160, v123
    v_dot2_f32_bf16 v125, v27, v160, v125
    v_dot2_f32_bf16 v121, v35, v160, v121
    v_dot2_f32_bf16 v122, v20, v160, v122
    v_dot2_f32_bf16 v124, v28, v160, v124
    v_dot2_f32_bf16 v120, v36, v160, v120
    v_dot2_f32_bf16 v123, v21, v160, v123
    v_dot2_f32_bf16 v125, v29, v160, v125
    v_dot2_f32_bf16 v121, v37, v160, v121
    v_dot2_f32_bf16 v122, v22, v160, v122
    v_dot2_f32_bf16 v124, v30, v160, v124
    v_dot2_f32_bf16 v120, v38, v160, v120
    v_dot2_f32_bf16 v123, v23, v160, v123
    v_dot2_f32_bf16 v125, v31, v160, v125
    v_dot2_f32_bf16 v121, v39, v160, v121
    s_nop 0
    v_add_f32 v122, v122, v123
    v_add_f32 v124, v124, v125
    v_add_f32 v120, v120, v121
    v_add_f32_dpp v122, v122, v122 quad_perm:[1,0,3,2] row_mask:0xf bank_mask:0xf
    v_add_f32_dpp v124, v124, v124 quad_perm:[1,0,3,2] row_mask:0xf bank_mask:0xf
    v_add_f32_dpp v120, v120, v120 quad_perm:[1,0,3,2] row_mask:0xf bank_mask:0xf
    v_add_f32_dpp v122, v122, v122 quad_perm:[2,3,0,1] row_mask:0xf bank_mask:0xf
    v_add_f32_dpp v124, v124, v124 quad_perm:[2,3,0,1] row_mask:0xf bank_mask:0xf
    v_add_f32_dpp v120, v120, v120 quad_perm:[2,3,0,1] row_mask:0xf bank_mask:0xf
    v_add_f32_dpp v122, v122, v122 row_half_mirror row_mask:0xf bank_mask:0xf
    v_add_f32_dpp v124, v124, v124 row_half_mirror row_mask:0xf bank_mask:0xf
    v_add_f32_dpp v120, v120, v120 row_half_mirror row_mask:0xf bank_mask:0xf
    v_add_f32_dpp v122, v122, v122 row_mirror row_mask:0xf bank_mask:0xf
    v_add_f32_dpp v124, v124, v124 row_mirror row_mask:0xf bank_mask:0xf
    v_add_f32_dpp v120, v120, v120 row_mirror row_mask:0xf bank_mask:0xf
    v_mov_b32 v123, v122
    v_mov_b32 v125, v124
    v_mov_b32 v121, v120
    v_permlane16_swap_b32 v122, v123
    v_permlane16_swap_b32 v124, v125
    v_permlane16_swap_b32 v120, v121
    v_add_f32 v122, v122, v123
    v_add_f32 v124, v124, v125
    v_add_f32 v120, v120, v121
    v_mul_f32 v122, 0xbb000000, v122
    v_mul_f32 v124, 0xbb000000, v124
    v_mul_f32 v120, 0xbb000000, v120
    s_xor_b32 s60, s59, 16384
    v_add_u32 v7, s60, v2
    v_dot2_f32_bf16 v104, v16, v161, v122
    v_dot2_f32_bf16 v105, v16, v162, v122
    v_dot2_f32_bf16 v106, v17, v161, v122
    v_dot2_f32_bf16 v107, v17, v162, v122
    v_dot2_f32_bf16 v108, v18, v161, v122
    v_dot2_f32_bf16 v109, v18, v162, v122
    v_dot2_f32_bf16 v110, v19, v161, v122
    v_dot2_f32_bf16 v111, v19, v162, v122
    v_dot2_f32_bf16 v112, v20, v161, v122
    v_dot2_f32_bf16 v113, v20, v162, v122
    v_dot2_f32_bf16 v114, v21, v161, v122
    v_dot2_f32_bf16 v115, v21, v162, v122
    v_dot2_f32_bf16 v116, v22, v161, v122
    v_dot2_f32_bf16 v117, v22, v162, v122
    v_dot2_f32_bf16 v118, v23, v161, v122
    v_dot2_f32_bf16 v119, v23, v162, v122
    v_cvt_pk_bf16_f32 v16, v104, v105
    v_cvt_pk_bf16_f32 v17, v106, v107
    v_cvt_pk_bf16_f32 v18, v108, v109
    v_cvt_pk_bf16_f32 v19, v110, v111
    ds_write_b128 v7, v[16:19]
    v_cvt_pk_bf16_f32 v20, v112, v113
    v_cvt_pk_bf16_f32 v21, v114, v115
    v_cvt_pk_bf16_f32 v22, v116, v117
    v_cvt_pk_bf16_f32 v23, v118, v119
    ds_write_b128 v7, v[20:23] offset:512
    s_xor_b32 s60, s59, 32768
    v_add_u32 v7, s60, v2
    v_dot2_f32_bf16 v104, v24, v161, v124
    v_dot2_f32_bf16 v105, v24, v162, v124
    v_dot2_f32_bf16 v106, v25, v161, v124
    v_dot2_f32_bf16 v107, v25, v162, v124
    v_dot2_f32_bf16 v108, v26, v161, v124
    v_dot2_f32_bf16 v109, v26, v162, v124
    v_dot2_f32_bf16 v110, v27, v161, v124
    v_dot2_f32_bf16 v111, v27, v162, v124
    v_dot2_f32_bf16 v112, v28, v161, v124
    v_dot2_f32_bf16 v113, v28, v162, v124
    v_dot2_f32_bf16 v114, v29, v161, v124
    v_dot2_f32_bf16 v115, v29, v162, v124
    v_dot2_f32_bf16 v116, v30, v161, v124
    v_dot2_f32_bf16 v117, v30, v162, v124
    v_dot2_f32_bf16 v118, v31, v161, v124
    v_dot2_f32_bf16 v119, v31, v162, v124
    v_cvt_pk_bf16_f32 v24, v104, v105
    v_cvt_pk_bf16_f32 v25, v106, v107
    v_cvt_pk_bf16_f32 v26, v108, v109
    v_cvt_pk_bf16_f32 v27, v110, v111
    ds_write_b128 v7, v[24:27]
    v_cvt_pk_bf16_f32 v28, v112, v113
    v_cvt_pk_bf16_f32 v29, v114, v115
    v_cvt_pk_bf16_f32 v30, v116, v117
    v_cvt_pk_bf16_f32 v31, v118, v119
    ds_write_b128 v7, v[28:31] offset:512
    s_xor_b32 s60, s59, 49152
    v_add_u32 v7, s60, v2
    v_dot2_f32_bf16 v104, v32, v161, v120
    v_dot2_f32_bf16 v105, v32, v162, v120
    v_dot2_f32_bf16 v106, v33, v161, v120
    v_dot2_f32_bf16 v107, v33, v162, v120
    v_dot2_f32_bf16 v108, v34, v161, v120
    v_dot2_f32_bf16 v109, v34, v162, v120
    v_dot2_f32_bf16 v110, v35, v161, v120
    v_dot2_f32_bf16 v111, v35, v162, v120
    v_dot2_f32_bf16 v112, v36, v161, v120
    v_dot2_f32_bf16 v113, v36, v162, v120
    v_dot2_f32_bf16 v114, v37, v161, v120
    v_dot2_f32_bf16 v115, v37, v162, v120
    v_dot2_f32_bf16 v116, v38, v161, v120
    v_dot2_f32_bf16 v117, v38, v162, v120
    v_dot2_f32_bf16 v118, v39, v161, v120
    v_dot2_f32_bf16 v119, v39, v162, v120
    v_cvt_pk_bf16_f32 v32, v104, v105
    v_cvt_pk_bf16_f32 v33, v106, v107
    v_cvt_pk_bf16_f32 v34, v108, v109
    v_cvt_pk_bf16_f32 v35, v110, v111
    ds_write_b128 v7, v[32:35]
    v_cvt_pk_bf16_f32 v36, v112, v113
    v_cvt_pk_bf16_f32 v37, v114, v115
    v_cvt_pk_bf16_f32 v38, v116, v117
    v_cvt_pk_bf16_f32 v39, v118, v119
    ds_write_b128 v7, v[36:39] offset:512
    v_mov_b32 v2, 1
    s_mov_b64 exec, 1
    ds_add_u32 v152, v2 offset:60
    s_mov_b64 exec, -1
    s_setprio 0
    s_mov_b32 s60, 0xffff0000
    v_lshlrev_b32 v104, 16, v16
    v_and_b32 v105, s60, v16
    v_lshlrev_b32 v106, 16, v17
    v_and_b32 v107, s60, v17
    v_lshlrev_b32 v108, 16, v18
    v_and_b32 v109, s60, v18
    v_lshlrev_b32 v110, 16, v19
    v_and_b32 v111, s60, v19
    v_lshlrev_b32 v112, 16, v20
    v_and_b32 v113, s60, v20
    v_lshlrev_b32 v114, 16, v21
    v_and_b32 v115, s60, v21
    v_lshlrev_b32 v116, 16, v22
    v_and_b32 v117, s60, v22
    v_lshlrev_b32 v118, 16, v23
    v_and_b32 v119, s60, v23
    v_pk_mul_f32 v[122:123], v[104:105], v[104:105]
    v_pk_fma_f32 v[122:123], v[106:107], v[106:107], v[122:123]
    v_pk_fma_f32 v[122:123], v[108:109], v[108:109], v[122:123]
    v_pk_fma_f32 v[122:123], v[110:111], v[110:111], v[122:123]
    v_pk_fma_f32 v[122:123], v[112:113], v[112:113], v[122:123]
    v_pk_fma_f32 v[122:123], v[114:115], v[114:115], v[122:123]
    v_pk_fma_f32 v[122:123], v[116:117], v[116:117], v[122:123]
    v_pk_fma_f32 v[122:123], v[118:119], v[118:119], v[122:123]
    v_lshlrev_b32 v104, 16, v24
    v_and_b32 v105, s60, v24
    v_lshlrev_b32 v106, 16, v25
    v_and_b32 v107, s60, v25
    v_lshlrev_b32 v108, 16, v26
    v_and_b32 v109, s60, v26
    v_lshlrev_b32 v110, 16, v27
    v_and_b32 v111, s60, v27
    v_lshlrev_b32 v112, 16, v28
    v_and_b32 v113, s60, v28
    v_lshlrev_b32 v114, 16, v29
    v_and_b32 v115, s60, v29
    v_lshlrev_b32 v116, 16, v30
    v_and_b32 v117, s60, v30
    v_lshlrev_b32 v118, 16, v31
    v_and_b32 v119, s60, v31
    v_pk_mul_f32 v[124:125], v[104:105], v[104:105]
    v_pk_fma_f32 v[124:125], v[106:107], v[106:107], v[124:125]
    v_pk_fma_f32 v[124:125], v[108:109], v[108:109], v[124:125]
    v_pk_fma_f32 v[124:125], v[110:111], v[110:111], v[124:125]
    v_pk_fma_f32 v[124:125], v[112:113], v[112:113], v[124:125]
    v_pk_fma_f32 v[124:125], v[114:115], v[114:115], v[124:125]
    v_pk_fma_f32 v[124:125], v[116:117], v[116:117], v[124:125]
    v_pk_fma_f32 v[124:125], v[118:119], v[118:119], v[124:125]
    v_lshlrev_b32 v104, 16, v32
    v_and_b32 v105, s60, v32
    v_lshlrev_b32 v106, 16, v33
    v_and_b32 v107, s60, v33
    v_lshlrev_b32 v108, 16, v34
    v_and_b32 v109, s60, v34
    v_lshlrev_b32 v110, 16, v35
    v_and_b32 v111, s60, v35
    v_lshlrev_b32 v112, 16, v36
    v_and_b32 v113, s60, v36
    v_lshlrev_b32 v114, 16, v37
    v_and_b32 v115, s60, v37
    v_lshlrev_b32 v116, 16, v38
    v_and_b32 v117, s60, v38
    v_lshlrev_b32 v118, 16, v39
    v_and_b32 v119, s60, v39
    v_pk_mul_f32 v[120:121], v[104:105], v[104:105]
    v_pk_fma_f32 v[120:121], v[106:107], v[106:107], v[120:121]
    v_pk_fma_f32 v[120:121], v[108:109], v[108:109], v[120:121]
    v_pk_fma_f32 v[120:121], v[110:111], v[110:111], v[120:121]
    v_pk_fma_f32 v[120:121], v[112:113], v[112:113], v[120:121]
    v_pk_fma_f32 v[120:121], v[114:115], v[114:115], v[120:121]
    v_pk_fma_f32 v[120:121], v[116:117], v[116:117], v[120:121]
    v_pk_fma_f32 v[120:121], v[118:119], v[118:119], v[120:121]
    v_add_f32 v122, v122, v123
    v_add_f32 v124, v124, v125
    v_add_f32 v120, v120, v121
    v_add_f32_dpp v122, v122, v122 quad_perm:[1,0,3,2] row_mask:0xf bank_mask:0xf
    v_add_f32_dpp v124, v124, v124 quad_perm:[1,0,3,2] row_mask:0xf bank_mask:0xf
    v_add_f32_dpp v120, v120, v120 quad_perm:[1,0,3,2] row_mask:0xf bank_mask:0xf
    v_add_f32_dpp v122, v122, v122 quad_perm:[2,3,0,1] row_mask:0xf bank_mask:0xf
    v_add_f32_dpp v124, v124, v124 quad_perm:[2,3,0,1] row_mask:0xf bank_mask:0xf
    v_add_f32_dpp v120, v120, v120 quad_perm:[2,3,0,1] row_mask:0xf bank_mask:0xf
    v_add_f32_dpp v122, v122, v122 row_half_mirror row_mask:0xf bank_mask:0xf
    v_add_f32_dpp v124, v124, v124 row_half_mirror row_mask:0xf bank_mask:0xf
    v_add_f32_dpp v120, v120, v120 row_half_mirror row_mask:0xf bank_mask:0xf
    v_add_f32_dpp v122, v122, v122 row_mirror row_mask:0xf bank_mask:0xf
    v_add_f32_dpp v124, v124, v124 row_mirror row_mask:0xf bank_mask:0xf
    v_add_f32_dpp v120, v120, v120 row_mirror row_mask:0xf bank_mask:0xf
    v_mov_b32 v123, v122
    v_mov_b32 v125, v124
    v_mov_b32 v121, v120
    v_permlane16_swap_b32 v122, v123
    v_permlane16_swap_b32 v124, v125
    v_permlane16_swap_b32 v120, v121
    v_add_f32 v122, v122, v123
    v_add_f32 v124, v124, v125
    v_add_f32 v120, v120, v121
    v_mov_b32 v7, 0x3727c5ac
    v_fma_f32 v122, v122, s57, v7
    v_fma_f32 v124, v124, s57, v7
    v_fma_f32 v120, v120, s57, v7
    v_rsq_f32 v122, v122
    v_rsq_f32 v124, v124
    v_rsq_f32 v120, v120
    s_xor_b32 s60, s59, 16384
    s_lshr_b32 s60, s60, 8
    v_add_u32 v123, s60, v3
    ds_write_b32 v123, v122
    s_xor_b32 s60, s59, 32768
    s_lshr_b32 s60, s60, 8
    v_add_u32 v125, s60, v3
    ds_write_b32 v125, v124
    s_xor_b32 s60, s59, 49152
    s_lshr_b32 s60, s60, 8
    v_add_u32 v121, s60, v3
    ds_write_b32 v121, v120
    v_mov_b32 v2, 1
    s_mov_b64 exec, 1
    ds_add_u32 v152, v2 offset:24
    s_mov_b64 exec, -1
    s_mov_b32 s63, 0
spin_1:
    ds_read_b32 v2, v152 offset:56
    s_add_u32 s63, s63, 1
    s_waitcnt lgkmcnt(0)
    v_readfirstlane_b32 s62, v2
    s_cmp_gt_u32 s63, 131072
    s_cbranch_scc1 spun_2
    s_cmp_ge_u32 s62, 1
    s_cbranch_scc1 spun_2
    s_sleep 1
    s_branch spin_1
spun_2:
    ds_read_b64 v[8:9], v152 offset:32
    s_add_u32 s45, s3, s5
    s_and_b32 s45, s45, 7
    s_lshl_b32 s61, s45, 13
    s_add_u32 s57, s61, 4096
    s_add_u32 s59, s61, 65536
    s_add_u32 s60, s61, 69632
    s_lshr_b32 s62, s3, 2
    s_and_b32 s58, s3, 3
    s_mul_i32 s0, s62, 1536
    s_sub_u32 s1, 153088, s0
    s_add_u32 s0, s0, 151552
    s_mul_i32 s54, s58, 2304
    s_add_u32 s54, s54, 114688
    s_mul_i32 s62, s62, 9216
    s_sub_u32 s55, s54, s62
    s_add_u32 s55, s55, 9216
    s_add_u32 s54, s54, s62
    s_waitcnt lgkmcnt(0)
    v_readfirstlane_b32 s52, v8
    v_readfirstlane_b32 s53, v9
    s_cmp_lg_u32 s3, 0
    s_cbranch_scc1 L_nokt
    s_lshl_b32 s58, s4, 8
    s_add_u32 s58, s58, 131072
    s_sleep 4
    s_mov_b32 s63, 0
poll_3:
    buffer_load_dwordx2 v[12:13], v159, s[40:43], s58 offen sc1
poll_3w:
    s_add_u32 s63, s63, 1
    s_waitcnt vmcnt(0)
    v_cmp_ne_u64 vcc, s[52:53], v[12:13]
    s_cmp_gt_u32 s63, 131072
    s_cbranch_scc1 polled_4
    s_cbranch_vccz polled_4
    s_sleep 2
    s_branch poll_3
polled_4:
    s_lshl_b32 s58, s4, 11
    v_add_u32 v12, 147456, v156
    buffer_load_dwordx4 v[8:11], v156, s[40:43], s58 offen sc1
    buffer_load_dwordx4 v[16:19], v156, s[40:43], s58 offen offset:1024 sc1
    v_mov_b32 v2, 1
    s_mov_b64 exec, 1
    ds_add_u32 v152, v2 offset:56
    s_mov_b64 exec, -1
    s_lshl_b32 s58, s45, 10
    s_add_u32 s58, s58, 131072
    s_nop 0
    buffer_load_dwordx2 v[14:15], v158, s[40:43], s58 offen sc1
    s_waitcnt vmcnt(1)
    ds_write_b128 v12, v[8:11]
    ds_write_b128 v12, v[16:19] offset:1024
    v_mov_b32 v2, 1
    s_mov_b64 exec, 1
    ds_add_u32 v152, v2 offset:24
    s_mov_b64 exec, -1
L_nokt:
    s_mov_b32 s47, 5
    s_cmp_eq_u32 s3, 0
    s_cselect_b32 s36, s20, s24
    s_cselect_b32 s37, s21, s25
    s_cmp_eq_u32 s3, 2
    s_cselect_b32 s36, s16, s36
    s_cselect_b32 s37, s17, s37
    s_mov_b32 s62, 5504
    s_cselect_b32 s62, 2048, s62
    s_mul_i32 s46, s2, s62
    s_sub_u32 s58, s3, 1
    s_cmp_lt_u32 s58, 2
    s_cbranch_scc1 L_touch
    s_mov_b32 s36, s32
    s_mov_b32 s37, s33
    s_lshl_b32 s46, s4, 4
    s_add_u32 s46, s46, s5
    s_lshl_b32 s46, s46, 12
    s_add_u32 s46, s46, 264192
    s_lshl_b32 s58, s4, 3
    s_add_u32 s58, s58, s5
    s_lshl_b32 s58, s58, 7
    s_add_u32 s58, s58, 163840
    s_cmp_lt_u32 s3, 5
    s_cselect_b32 s46, s46, s58
    s_cselect_b32 s62, 2048, 64
    s_and_b32 s58, s3, 1
    s_lshl_b32 s58, s58, 15
    s_add_u32 s46, s46, s58
    s_sub_u32 s44, s3, 1
    s_cmp_lt_u32 s44, 6
    s_cbranch_scc1 L_touch
    s_mov_b32 s36, s28
    s_mov_b32 s37, s29
    s_lshl_b32 s46, s4, 16
    s_add_u32 s46, s46, s58
    s_lshl_b32 s58, s5, 7
    s_add_u32 s46, s46, s58
    s_mov_b32 s62, 0
    s_mov_b32 s47, 8
L_touch:
    s_add_u32 s38, s46, s62
    s_mov_b32 s39, 0x20000
    s_mov_b32 m0, 154368
    s_mov_b32 s63, 0
spin_5:
    ds_read_b32 v2, v152 offset:56
    s_add_u32 s63, s63, 1
    s_waitcnt lgkmcnt(0)
    v_readfirstlane_b32 s62, v2
    s_cmp_gt_u32 s63, 131072
    s_cbranch_scc1 spun_6
    s_cmp_ge_u32 s62, 2
    s_cbranch_scc1 spun_6
    s_sleep 1
    s_branch spin_5
spun_6:
    s_lshl_b32 s58, s45, 10
    s_add_u32 s58, s58, 131072
    s_mov_b32 s63, 0
    s_cmp_eq_u32 s3, 0
    s_cbranch_scc1 poll_7w
poll_7:
    buffer_load_dwordx2 v[14:15], v158, s[40:43], s58 offen sc1
poll_7w:
    s_add_u32 s63, s63, 1
    s_waitcnt vmcnt(0)
    v_cmp_ne_u64 vcc, s[52:53], v[14:15]
    s_cmp_gt_u32 s63, 131072
    s_cbranch_scc1 polled_8
    s_cbranch_vccz polled_8
    s_sleep 4
    s_branch poll_7
polled_8:
    buffer_load_dwordx4 v[8:11], v156, s[40:43], s61 offen offset:0 sc1
    buffer_load_dwordx4 v[12:15], v156, s[40:43], s61 offen offset:1024 sc1
    buffer_load_dwordx4 v[40:43], v156, s[40:43], s59 offen offset:0 sc1
    buffer_load_dwordx4 v[16:19], v156, s[40:43], s61 offen offset:2048 sc1
    buffer_load_dwordx4 v[48:51], v156, s[40:43], s59 offen offset:1024 sc1
    buffer_load_dwordx4 v[20:23], v156, s[40:43], s61 offen offset:3072 sc1
    buffer_load_dwordx4 v[56:59], v156, s[40:43], s59 offen offset:2048 sc1
    buffer_load_dwordx4 v[24:27], v156, s[40:43], s57 offen offset:0 sc1
    buffer_load_dwordx4 v[64:67], v156, s[40:43], s59 offen offset:3072 sc1
    buffer_load_dwordx4 v[28:31], v156, s[40:43], s57 offen offset:1024 sc1
    buffer_load_dwordx4 v[72:75], v156, s[40:43], s60 offen offset:0 sc1
    buffer_load_dwordx4 v[32:35], v156, s[40:43], s57 offen offset:2048 sc1
    buffer_load_dwordx4 v[80:83], v156, s[40:43], s60 offen offset:1024 sc1
    buffer_load_dwordx4 v[36:39], v156, s[40:43], s57 offen offset:3072 sc1
    buffer_load_dwordx4 v[88:91], v156, s[40:43], s60 offen offset:2048 sc1
    buffer_load_dwordx4 v[96:99], v156, s[40:43], s60 offen offset:3072 sc1
    v_mov_b32 v2, 1
    s_mov_b64 exec, 1
    ds_add_u32 v152, v2 offset:20
    s_mov_b64 exec, -1
    s_mov_b32 s63, 0
spin_9:
    ds_read_b32 v2, v152 offset:0
    s_add_u32 s63, s63, 1
    s_waitcnt lgkmcnt(0)
    v_readfirstlane_b32 s62, v2
    s_cmp_gt_u32 s63, 131072
    s_cbranch_scc1 spun_10
    s_cmp_lt_u32 s62, 4
    s_cbranch_scc1 spin_9
spun_10:
    v_lshl_add_u32 v2, v0, 2, s0
    v_add_u32 v3, s0, v0
    ds_read_b128 v[4:7], v2 offset:0
    ds_read_b32 v3, v3 offset:1024
    s_setprio 2
    s_add_u32 s48, s52, 1
    s_add_u32 s49, s52, 2
    s_add_u32 s50, s52, 3
    s_add_u32 s51, s52, 4
    v_mov_b32 v1, 0x3f80dddd
    v_mov_b32 v136, 0
    v_mov_b64 v[144:145], 0
    v_mov_b64 v[146:147], 0
    v_mov_b64 v[148:149], 0
    v_mov_b64 v[150:151], 0
    s_waitcnt lgkmcnt(0)
    v_mfma_f32_32x32x8_bf16 v[152:167], v[0:1], v[2:3], 0
    s_waitcnt vmcnt(15)
    s_nop 0
    v_mfma_f32_32x32x16_bf16 v[104:119], v[8:11], v[4:7], v[152:167]
    s_nop 10
    s_waitcnt vmcnt(14)
L_atop:
    v_exp_f32 v104, v104
    v_exp_f32 v105, v105
    v_exp_f32 v106, v106
    v_exp_f32 v107, v107
    v_exp_f32 v108, v108
    v_mfma_f32_32x32x16_bf16 v[120:135], v[12:15], v[4:7], v[152:167]
    v_exp_f32 v109, v109
    v_exp_f32 v110, v110
    v_exp_f32 v111, v111
    s_waitcnt vmcnt(12)
    v_permlane16_swap_b32 v44, v40
    v_permlane16_swap_b32 v45, v41
    v_permlane16_swap_b32 v46, v42
    v_permlane16_swap_b32 v47, v43
    v_exp_f32 v112, v112
    v_exp_f32 v113, v113
    v_exp_f32 v114, v114
    v_smfmac_f32_32x32x32_bf16 v[136:151], v[40:43], v[104:111], v1
    v_exp_f32 v115, v115
    v_exp_f32 v116, v116
    v_exp_f32 v117, v117
    v_exp_f32 v118, v118
    v_exp_f32 v119, v119
    v_exp_f32 v120, v120
    v_exp_f32 v121, v121
    v_smfmac_f32_32x32x32_bf16 v[136:151], v[44:47], v[112:119], v1
    v_exp_f32 v122, v122
    v_exp_f32 v123, v123
    v_exp_f32 v124, v124
    v_mfma_f32_32x32x16_bf16 v[104:119], v[16:19], v[4:7], v[152:167]
    v_exp_f32 v125, v125
    v_exp_f32 v126, v126
    v_exp_f32 v127, v127
    s_waitcnt vmcnt(10)
    v_permlane16_swap_b32 v52, v48
    v_permlane16_swap_b32 v53, v49
    v_permlane16_swap_b32 v54, v50
    v_permlane16_swap_b32 v55, v51
    v_exp_f32 v128, v128
    v_exp_f32 v129, v129
    v_exp_f32 v130, v130
    v_smfmac_f32_32x32x32_bf16 v[136:151], v[48:51], v[120:127], v1
    v_exp_f32 v131, v131
    v_exp_f32 v132, v132
    v_exp_f32 v133, v133
    v_exp_f32 v134, v134
    v_exp_f32 v135, v135
    v_exp_f32 v104, v104
    v_exp_f32 v105, v105
    v_smfmac_f32_32x32x32_bf16 v[136:151], v[52:55], v[128:135], v1
    v_exp_f32 v106, v106
    v_exp_f32 v107, v107
    v_exp_f32 v108, v108
    v_mfma_f32_32x32x16_bf16 v[120:135], v[20:23], v[4:7], v[152:167]
    v_exp_f32 v109, v109
    v_exp_f32 v110, v110
    v_exp_f32 v111, v111
    s_waitcnt vmcnt(8)
    v_permlane16_swap_b32 v60, v56
    v_permlane16_swap_b32 v61, v57
    v_permlane16_swap_b32 v62, v58
    v_permlane16_swap_b32 v63, v59
    v_exp_f32 v112, v112
    v_exp_f32 v113, v113
    v_exp_f32 v114, v114
    v_smfmac_f32_32x32x32_bf16 v[136:151], v[56:59], v[104:111], v1
    v_exp_f32 v115, v115
    v_exp_f32 v116, v116
    v_exp_f32 v117, v117
    v_exp_f32 v118, v118
    v_exp_f32 v119, v119
    v_exp_f32 v120, v120
    v_exp_f32 v121, v121
    v_smfmac_f32_32x32x32_bf16 v[136:151], v[60:63], v[112:119], v1
    v_exp_f32 v122, v122
    v_exp_f32 v123, v123
    v_exp_f32 v124, v124
    v_mfma_f32_32x32x16_bf16 v[104:119], v[24:27], v[4:7], v[152:167]
    v_exp_f32 v125, v125
    v_exp_f32 v126, v126
    v_exp_f32 v127, v127
    s_waitcnt vmcnt(6)
    v_permlane16_swap_b32 v68, v64
    v_permlane16_swap_b32 v69, v65
    v_permlane16_swap_b32 v70, v66
    v_permlane16_swap_b32 v71, v67
    v_exp_f32 v128, v128
    v_exp_f32 v129, v129
    v_exp_f32 v130, v130
    v_smfmac_f32_32x32x32_bf16 v[136:151], v[64:67], v[120:127], v1
    v_exp_f32 v131, v131
    v_exp_f32 v132, v132
    v_exp_f32 v133, v133
    v_exp_f32 v134, v134
    v_exp_f32 v135, v135
    v_exp_f32 v104, v104
    v_exp_f32 v105, v105
    v_smfmac_f32_32x32x32_bf16 v[136:151], v[68:71], v[128:135], v1
    v_exp_f32 v106, v106
    v_exp_f32 v107, v107
    v_exp_f32 v108, v108
    v_mfma_f32_32x32x16_bf16 v[120:135], v[28:31], v[4:7], v[152:167]
    v_exp_f32 v109, v109
    v_exp_f32 v110, v110
    v_exp_f32 v111, v111
    s_waitcnt vmcnt(4)
    v_permlane16_swap_b32 v76, v72
    v_permlane16_swap_b32 v77, v73
    v_permlane16_swap_b32 v78, v74
    v_permlane16_swap_b32 v79, v75
    v_exp_f32 v112, v112
    v_exp_f32 v113, v113
    v_exp_f32 v114, v114
    v_smfmac_f32_32x32x32_bf16 v[136:151], v[72:75], v[104:111], v1
    v_exp_f32 v115, v115
    v_exp_f32 v116, v116
    v_exp_f32 v117, v117
    v_exp_f32 v118, v118
    v_exp_f32 v119, v119
    v_exp_f32 v120, v120
    v_exp_f32 v121, v121
    v_smfmac_f32_32x32x32_bf16 v[136:151], v[76:79], v[112:119], v1
    v_exp_f32 v122, v122
    v_exp_f32 v123, v123
    v_exp_f32 v124, v124
    v_mfma_f32_32x32x16_bf16 v[104:119], v[32:35], v[4:7], v[152:167]
    v_exp_f32 v125, v125
    v_exp_f32 v126, v126
    v_exp_f32 v127, v127
    s_waitcnt vmcnt(2)
    v_permlane16_swap_b32 v84, v80
    v_permlane16_swap_b32 v85, v81
    v_permlane16_swap_b32 v86, v82
    v_permlane16_swap_b32 v87, v83
    v_exp_f32 v128, v128
    v_exp_f32 v129, v129
    v_exp_f32 v130, v130
    v_smfmac_f32_32x32x32_bf16 v[136:151], v[80:83], v[120:127], v1
    v_exp_f32 v131, v131
    v_exp_f32 v132, v132
    v_exp_f32 v133, v133
    v_exp_f32 v134, v134
    v_exp_f32 v135, v135
    v_exp_f32 v104, v104
    v_exp_f32 v105, v105
    v_smfmac_f32_32x32x32_bf16 v[136:151], v[84:87], v[128:135], v1
    v_exp_f32 v106, v106
    v_lshl_add_u32 v2, v0, 2, s0
    v_add_u32 v3, s0, v0
    v_exp_f32 v107, v107
    v_exp_f32 v108, v108
    v_mfma_f32_32x32x16_bf16 v[120:135], v[36:39], v[4:7], v[152:167]
    v_exp_f32 v109, v109
    ds_read_b128 v[4:7], v2 offset:3072
    ds_read_b32 v3, v3 offset:4096
    v_exp_f32 v110, v110
    v_exp_f32 v111, v111
    s_waitcnt vmcnt(1)
    v_permlane16_swap_b32 v92, v88
    v_permlane16_swap_b32 v93, v89
    v_permlane16_swap_b32 v94, v90
    v_permlane16_swap_b32 v95, v91
    v_exp_f32 v112, v112
    v_exp_f32 v113, v113
    v_smfmac_f32_32x32x32_bf16 v[136:151], v[88:91], v[104:111], v1
    v_exp_f32 v114, v114
    v_exp_f32 v115, v115
    v_exp_f32 v116, v116
    v_exp_f32 v117, v117
    s_waitcnt lgkmcnt(0)
    v_mfma_f32_32x32x8_bf16 v[152:167], v[0:1], v[2:3], 0
    v_exp_f32 v118, v118
    v_exp_f32 v119, v119
    v_exp_f32 v120, v120
    v_exp_f32 v121, v121
    v_exp_f32 v122, v122
    v_smfmac_f32_32x32x32_bf16 v[136:151], v[92:95], v[112:119], v1
    v_exp_f32 v123, v123
    v_exp_f32 v124, v124
    v_mfma_f32_32x32x16_bf16 v[104:119], v[8:11], v[4:7], v[152:167]
    v_exp_f32 v125, v125
    v_exp_f32 v126, v126
    v_exp_f32 v127, v127
    s_waitcnt vmcnt(0)
    v_permlane16_swap_b32 v100, v96
    v_permlane16_swap_b32 v101, v97
    v_permlane16_swap_b32 v102, v98
    v_permlane16_swap_b32 v103, v99
    s_sub_u32 s57, s3, 3
    s_cmp_lt_u32 s57, 2
    s_cbranch_scc1 nt_11
    v_lshlrev_b32 v3, s47, v0
    s_mov_b32 exec_hi, 0x7ff
    buffer_load_dword v3, s[36:39], s46 offen lds
    s_mov_b32 exec_hi, -1
nt_11:
    v_exp_f32 v128, v128
    v_exp_f32 v129, v129
    v_exp_f32 v130, v130
    v_exp_f32 v131, v131
    v_smfmac_f32_32x32x32_bf16 v[136:151], v[96:99], v[120:127], v1
    v_exp_f32 v132, v132
    v_exp_f32 v133, v133
    v_exp_f32 v134, v134
    v_exp_f32 v135, v135
    v_exp_f32 v104, v104
    v_exp_f32 v105, v105
    v_smfmac_f32_32x32x32_bf16 v[136:151], v[100:103], v[128:135], v1
    v_exp_f32 v106, v106
    v_exp_f32 v107, v107
    v_exp_f32 v108, v108
    v_mfma_f32_32x32x16_bf16 v[120:135], v[12:15], v[4:7], v[152:167]
    v_exp_f32 v109, v109
    v_exp_f32 v110, v110
    v_exp_f32 v111, v111
    v_exp_f32 v112, v112
    v_lshl_add_u32 v2, v0, 2, s54
    v_add_u32 v3, s54, v0
    v_exp_f32 v113, v113
    v_exp_f32 v114, v114
    v_writelane_b32 v136, s48, 63
    ds_write_b128 v2, v[144:147] offset:0
    v_exp_f32 v115, v115
    ds_write_b128 v2, v[148:151] offset:1024
    v_exp_f32 v116, v116
    ds_write_b32 v3, v136 offset:2048
    v_exp_f32 v117, v117
    v_mov_b32 v136, 0
    v_mov_b64 v[144:145], 0
    v_mov_b64 v[146:147], 0
    v_mov_b64 v[148:149], 0
    v_mov_b64 v[150:151], 0
    v_exp_f32 v118, v118
    v_exp_f32 v119, v119
    v_smfmac_f32_32x32x32_bf16 v[136:151], v[40:43], v[104:111], v1
    v_exp_f32 v120, v120
    v_exp_f32 v121, v121
    v_exp_f32 v122, v122
    v_smfmac_f32_32x32x32_bf16 v[136:151], v[44:47], v[112:119], v1
    v_exp_f32 v123, v123
    v_exp_f32 v124, v124
    v_mfma_f32_32x32x16_bf16 v[104:119], v[16:19], v[4:7], v[152:167]
    v_exp_f32 v125, v125
    v_exp_f32 v126, v126
    v_exp_f32 v127, v127
    v_exp_f32 v128, v128
    v_exp_f32 v129, v129
    v_exp_f32 v130, v130
    v_exp_f32 v131, v131
    v_smfmac_f32_32x32x32_bf16 v[136:151], v[48:51], v[120:127], v1
    v_exp_f32 v132, v132
    v_exp_f32 v133, v133
    v_exp_f32 v134, v134
    v_exp_f32 v135, v135
    s_setprio 1
    v_exp_f32 v104, v104
    v_exp_f32 v105, v105
    v_smfmac_f32_32x32x32_bf16 v[136:151], v[52:55], v[128:135], v1
    v_exp_f32 v106, v106
    v_exp_f32 v107, v107
    v_exp_f32 v108, v108
    v_mfma_f32_32x32x16_bf16 v[120:135], v[20:23], v[4:7], v[152:167]
    v_exp_f32 v109, v109
    v_exp_f32 v110, v110
    v_exp_f32 v111, v111
    v_exp_f32 v112, v112
    v_exp_f32 v113, v113
    v_exp_f32 v114, v114
    v_smfmac_f32_32x32x32_bf16 v[136:151], v[56:59], v[104:111], v1
    v_exp_f32 v115, v115
    v_exp_f32 v116, v116
    v_exp_f32 v117, v117
    v_exp_f32 v118, v118
    v_exp_f32 v119, v119
    v_exp_f32 v120, v120
    v_exp_f32 v121, v121
    v_smfmac_f32_32x32x32_bf16 v[136:151], v[60:63], v[112:119], v1
    v_exp_f32 v122, v122
    v_exp_f32 v123, v123
    v_exp_f32 v124, v124
    v_mfma_f32_32x32x16_bf16 v[104:119], v[24:27], v[4:7], v[152:167]
    v_exp_f32 v125, v125
    v_exp_f32 v126, v126
    v_exp_f32 v127, v127
    v_exp_f32 v128, v128
    v_exp_f32 v129, v129
    v_exp_f32 v130, v130
    v_smfmac_f32_32x32x32_bf16 v[136:151], v[64:67], v[120:127], v1
    v_exp_f32 v131, v131
    v_exp_f32 v132, v132
    v_exp_f32 v133, v133
    v_exp_f32 v134, v134
    v_exp_f32 v135, v135
    v_exp_f32 v104, v104
    v_exp_f32 v105, v105
    v_smfmac_f32_32x32x32_bf16 v[136:151], v[68:71], v[128:135], v1
    v_exp_f32 v106, v106
    v_exp_f32 v107, v107
    v_exp_f32 v108, v108
    v_mfma_f32_32x32x16_bf16 v[120:135], v[28:31], v[4:7], v[152:167]
    v_exp_f32 v109, v109
    v_exp_f32 v110, v110
    v_exp_f32 v111, v111
    v_exp_f32 v112, v112
    v_exp_f32 v113, v113
    v_exp_f32 v114, v114
    v_smfmac_f32_32x32x32_bf16 v[136:151], v[72:75], v[104:111], v1
    v_exp_f32 v115, v115
    v_exp_f32 v116, v116
    v_exp_f32 v117, v117
    v_exp_f32 v118, v118
    v_exp_f32 v119, v119
    v_exp_f32 v120, v120
    v_exp_f32 v121, v121
    v_smfmac_f32_32x32x32_bf16 v[136:151], v[76:79], v[112:119], v1
    v_exp_f32 v122, v122
    v_exp_f32 v123, v123
    v_exp_f32 v124, v124
    v_mfma_f32_32x32x16_bf16 v[104:119], v[32:35], v[4:7], v[152:167]
    v_exp_f32 v125, v125
    v_exp_f32 v126, v126
    v_exp_f32 v127, v127
    v_exp_f32 v128, v128
    v_exp_f32 v129, v129
    v_exp_f32 v130, v130
    v_smfmac_f32_32x32x32_bf16 v[136:151], v[80:83], v[120:127], v1
    v_exp_f32 v131, v131
    v_exp_f32 v132, v132
    v_exp_f32 v133, v133
    v_exp_f32 v134, v134
    v_exp_f32 v135, v135
    v_exp_f32 v104, v104
    v_exp_f32 v105, v105
    v_smfmac_f32_32x32x32_bf16 v[136:151], v[84:87], v[128:135], v1
    v_exp_f32 v106, v106
    v_lshl_add_u32 v2, v0, 2, s1
    v_add_u32 v3, s1, v0
    v_exp_f32 v107, v107
    v_exp_f32 v108, v108
    v_mfma_f32_32x32x16_bf16 v[120:135], v[36:39], v[4:7], v[152:167]
    v_exp_f32 v109, v109
    ds_read_b128 v[4:7], v2 offset:0
    ds_read_b32 v3, v3 offset:1024
    v_exp_f32 v110, v110
    v_exp_f32 v111, v111
    v_exp_f32 v112, v112
    v_exp_f32 v113, v113
    v_smfmac_f32_32x32x32_bf16 v[136:151], v[88:91], v[104:111], v1
    v_exp_f32 v114, v114
    v_exp_f32 v115, v115
    v_exp_f32 v116, v116
    v_exp_f32 v117, v117
    s_waitcnt lgkmcnt(0)
    v_mfma_f32_32x32x8_bf16 v[152:167], v[0:1], v[2:3], 0
    v_exp_f32 v118, v118
    v_exp_f32 v119, v119
    v_exp_f32 v120, v120
    v_exp_f32 v121, v121
    v_exp_f32 v122, v122
    v_smfmac_f32_32x32x32_bf16 v[136:151], v[92:95], v[112:119], v1
    v_exp_f32 v123, v123
    v_exp_f32 v124, v124
    v_mfma_f32_32x32x16_bf16 v[104:119], v[8:11], v[4:7], v[152:167]
    v_exp_f32 v125, v125
    v_exp_f32 v126, v126
    v_exp_f32 v127, v127
    v_exp_f32 v128, v128
    v_exp_f32 v129, v129
    v_exp_f32 v130, v130
    v_exp_f32 v131, v131
    v_smfmac_f32_32x32x32_bf16 v[136:151], v[96:99], v[120:127], v1
    v_exp_f32 v132, v132
    v_exp_f32 v133, v133
    v_exp_f32 v134, v134
    v_exp_f32 v135, v135
    v_exp_f32 v104, v104
    v_exp_f32 v105, v105
    v_smfmac_f32_32x32x32_bf16 v[136:151], v[100:103], v[128:135], v1
    v_exp_f32 v106, v106
    v_exp_f32 v107, v107
    v_exp_f32 v108, v108
    v_mfma_f32_32x32x16_bf16 v[120:135], v[12:15], v[4:7], v[152:167]
    v_exp_f32 v109, v109
    v_exp_f32 v110, v110
    v_exp_f32 v111, v111
    v_exp_f32 v112, v112
    v_lshl_add_u32 v2, v0, 2, s54
    v_add_u32 v3, s54, v0
    v_exp_f32 v113, v113
    v_exp_f32 v114, v114
    v_writelane_b32 v136, s48, 63
    ds_write_b128 v2, v[144:147] offset:18432
    ds_write_b128 v2, v[148:151] offset:19456
    ds_write_b32 v3, v136 offset:20480
    v_lshl_add_u32 v2, v0, 2, s55
    v_add_u32 v3, s55, v0
    ds_read_b32 v136, v3 offset:2048
    ds_read_b128 v[144:147], v2 offset:0
    ds_read_b128 v[148:151], v2 offset:1024
    v_exp_f32 v115, v115
    v_exp_f32 v116, v116
    v_exp_f32 v117, v117
    v_exp_f32 v118, v118
    v_exp_f32 v119, v119
L_got2:
    s_waitcnt lgkmcnt(0)
    v_readlane_b32 s57, v136, 63
    s_nop 0
    s_cmp_lg_u32 s57, s48
    s_cbranch_scc1 L_wait2
L_go2:
    v_smfmac_f32_32x32x32_bf16 v[136:151], v[40:43], v[104:111], v1
    v_exp_f32 v120, v120
    v_exp_f32 v121, v121
    v_exp_f32 v122, v122
    v_smfmac_f32_32x32x32_bf16 v[136:151], v[44:47], v[112:119], v1
    v_exp_f32 v123, v123
    v_exp_f32 v124, v124
    v_mfma_f32_32x32x16_bf16 v[104:119], v[16:19], v[4:7], v[152:167]
    v_exp_f32 v125, v125
    v_exp_f32 v126, v126
    v_exp_f32 v127, v127
    v_exp_f32 v128, v128
    v_exp_f32 v129, v129
    v_exp_f32 v130, v130
    v_exp_f32 v131, v131
    v_smfmac_f32_32x32x32_bf16 v[136:151], v[48:51], v[120:127], v1
    v_exp_f32 v132, v132
    v_exp_f32 v133, v133
    v_exp_f32 v134, v134
    v_exp_f32 v135, v135
    s_setprio 0
    v_exp_f32 v104, v104
    v_exp_f32 v105, v105
    v_smfmac_f32_32x32x32_bf16 v[136:151], v[52:55], v[128:135], v1
    v_exp_f32 v106, v106
    v_exp_f32 v107, v107
    v_exp_f32 v108, v108
    v_mfma_f32_32x32x16_bf16 v[120:135], v[20:23], v[4:7], v[152:167]
    v_exp_f32 v109, v109
    v_exp_f32 v110, v110
    v_exp_f32 v111, v111
    v_exp_f32 v112, v112
    v_exp_f32 v113, v113
    v_exp_f32 v114, v114
    v_smfmac_f32_32x32x32_bf16 v[136:151], v[56:59], v[104:111], v1
    v_exp_f32 v115, v115
    v_exp_f32 v116, v116
    v_exp_f32 v117, v117
    v_exp_f32 v118, v118
    v_exp_f32 v119, v119
    v_exp_f32 v120, v120
    v_exp_f32 v121, v121
    v_smfmac_f32_32x32x32_bf16 v[136:151], v[60:63], v[112:119], v1
    v_exp_f32 v122, v122
    v_exp_f32 v123, v123
    v_exp_f32 v124, v124
    v_mfma_f32_32x32x16_bf16 v[104:119], v[24:27], v[4:7], v[152:167]
    v_exp_f32 v125, v125
    v_exp_f32 v126, v126
    v_exp_f32 v127, v127
    v_exp_f32 v128, v128
    v_exp_f32 v129, v129
    v_exp_f32 v130, v130
    v_smfmac_f32_32x32x32_bf16 v[136:151], v[64:67], v[120:127], v1
    v_exp_f32 v131, v131
    v_exp_f32 v132, v132
    v_exp_f32 v133, v133
    v_exp_f32 v134, v134
    v_exp_f32 v135, v135
    s_setprio 2
    v_exp_f32 v104, v104
    v_exp_f32 v105, v105
    v_smfmac_f32_32x32x32_bf16 v[136:151], v[68:71], v[128:135], v1
    v_exp_f32 v106, v106
    v_exp_f32 v107, v107
    v_exp_f32 v108, v108
    v_mfma_f32_32x32x16_bf16 v[120:135], v[28:31], v[4:7], v[152:167]
    v_exp_f32 v109, v109
    v_exp_f32 v110, v110
    v_exp_f32 v111, v111
    v_exp_f32 v112, v112
    v_exp_f32 v113, v113
    v_exp_f32 v114, v114
    v_smfmac_f32_32x32x32_bf16 v[136:151], v[72:75], v[104:111], v1
    v_exp_f32 v115, v115
    v_exp_f32 v116, v116
    v_exp_f32 v117, v117
    v_exp_f32 v118, v118
    v_exp_f32 v119, v119
    v_exp_f32 v120, v120
    v_exp_f32 v121, v121
    v_smfmac_f32_32x32x32_bf16 v[136:151], v[76:79], v[112:119], v1
    v_exp_f32 v122, v122
    v_exp_f32 v123, v123
    v_exp_f32 v124, v124
    v_mfma_f32_32x32x16_bf16 v[104:119], v[32:35], v[4:7], v[152:167]
    v_exp_f32 v125, v125
    v_exp_f32 v126, v126
    v_exp_f32 v127, v127
    v_exp_f32 v128, v128
    v_exp_f32 v129, v129
    v_exp_f32 v130, v130
    v_smfmac_f32_32x32x32_bf16 v[136:151], v[80:83], v[120:127], v1
    v_exp_f32 v131, v131
    v_exp_f32 v132, v132
    v_exp_f32 v133, v133
    v_exp_f32 v134, v134
    v_exp_f32 v135, v135
    v_exp_f32 v104, v104
    v_exp_f32 v105, v105
    v_smfmac_f32_32x32x32_bf16 v[136:151], v[84:87], v[128:135], v1
    v_exp_f32 v106, v106
    v_lshl_add_u32 v2, v0, 2, s1
    v_add_u32 v3, s1, v0
    v_exp_f32 v107, v107
    v_exp_f32 v108, v108
    v_mfma_f32_32x32x16_bf16 v[120:135], v[36:39], v[4:7], v[152:167]
    v_exp_f32 v109, v109
    ds_read_b128 v[4:7], v2 offset:3072
    ds_read_b32 v3, v3 offset:4096
    v_exp_f32 v110, v110
    v_exp_f32 v111, v111
    v_exp_f32 v112, v112
    v_exp_f32 v113, v113
    v_smfmac_f32_32x32x32_bf16 v[136:151], v[88:91], v[104:111], v1
    v_exp_f32 v114, v114
    v_exp_f32 v115, v115
    v_exp_f32 v116, v116
    v_exp_f32 v117, v117
    s_waitcnt lgkmcnt(0)
    v_mfma_f32_32x32x8_bf16 v[152:167], v[0:1], v[2:3], 0
    v_exp_f32 v118, v118
    v_exp_f32 v119, v119
    v_exp_f32 v120, v120
    v_exp_f32 v121, v121
    v_exp_f32 v122, v122
    v_smfmac_f32_32x32x32_bf16 v[136:151], v[92:95], v[112:119], v1
    v_exp_f32 v123, v123
    v_exp_f32 v124, v124
    v_mfma_f32_32x32x16_bf16 v[104:119], v[8:11], v[4:7], v[152:167]
    v_exp_f32 v125, v125
    v_exp_f32 v126, v126
    v_exp_f32 v127, v127
    v_exp_f32 v128, v128
    v_exp_f32 v129, v129
    v_exp_f32 v130, v130
    v_exp_f32 v131, v131
    v_smfmac_f32_32x32x32_bf16 v[136:151], v[96:99], v[120:127], v1
    v_exp_f32 v132, v132
    v_exp_f32 v133, v133
    v_exp_f32 v134, v134
    v_exp_f32 v135, v135
    v_exp_f32 v104, v104
    v_exp_f32 v105, v105
    v_smfmac_f32_32x32x32_bf16 v[136:151], v[100:103], v[128:135], v1
    v_exp_f32 v106, v106
    v_exp_f32 v107, v107
    v_exp_f32 v108, v108
    v_mfma_f32_32x32x16_bf16 v[120:135], v[12:15], v[4:7], v[152:167]
    v_exp_f32 v109, v109
    v_exp_f32 v110, v110
    v_exp_f32 v111, v111
    v_exp_f32 v112, v112
    v_lshl_add_u32 v2, v0, 2, s55
    v_add_u32 v3, s55, v0
    v_exp_f32 v113, v113
    v_exp_f32 v114, v114
    v_writelane_b32 v136, s49, 63
    ds_write_b128 v2, v[144:147] offset:0
    ds_write_b128 v2, v[148:151] offset:1024
    ds_write_b32 v3, v136 offset:2048
    ds_read_b32 v136, v3 offset:20480
    ds_read_b128 v[144:147], v2 offset:18432
    ds_read_b128 v[148:151], v2 offset:19456
    v_exp_f32 v115, v115
    v_exp_f32 v116, v116
    v_exp_f32 v117, v117
    v_exp_f32 v118, v118
    v_exp_f32 v119, v119
L_got3:
    s_waitcnt lgkmcnt(0)
    v_readlane_b32 s57, v136, 63
    s_nop 0
    s_cmp_lg_u32 s57, s48
    s_cbranch_scc1 L_wait3
L_go3:
    v_smfmac_f32_32x32x32_bf16 v[136:151], v[40:43], v[104:111], v1
    v_exp_f32 v120, v120
    v_exp_f32 v121, v121
    v_exp_f32 v122, v122
    v_smfmac_f32_32x32x32_bf16 v[136:151], v[44:47], v[112:119], v1
    v_exp_f32 v123, v123
    v_exp_f32 v124, v124
    v_mfma_f32_32x32x16_bf16 v[104:119], v[16:19], v[4:7], v[152:167]
    v_exp_f32 v125, v125
    v_exp_f32 v126, v126
    v_exp_f32 v127, v127
    v_exp_f32 v128, v128
    v_exp_f32 v129, v129
    v_exp_f32 v130, v130
    v_exp_f32 v131, v131
    v_smfmac_f32_32x32x32_bf16 v[136:151], v[48:51], v[120:127], v1
    v_exp_f32 v132, v132
    v_exp_f32 v133, v133
    v_exp_f32 v134, v134
    v_exp_f32 v135, v135
    v_exp_f32 v104, v104
    v_exp_f32 v105, v105
    v_smfmac_f32_32x32x32_bf16 v[136:151], v[52:55], v[128:135], v1
    v_exp_f32 v106, v106
    v_exp_f32 v107, v107
    v_exp_f32 v108, v108
    v_mfma_f32_32x32x16_bf16 v[120:135], v[20:23], v[4:7], v[152:167]
    v_exp_f32 v109, v109
    v_exp_f32 v110, v110
    v_exp_f32 v111, v111
    v_exp_f32 v112, v112
    v_exp_f32 v113, v113
    v_exp_f32 v114, v114
    v_smfmac_f32_32x32x32_bf16 v[136:151], v[56:59], v[104:111], v1
    v_exp_f32 v115, v115
    v_exp_f32 v116, v116
    v_exp_f32 v117, v117
    v_exp_f32 v118, v118
    v_exp_f32 v119, v119
    v_exp_f32 v120, v120
    v_exp_f32 v121, v121
    v_smfmac_f32_32x32x32_bf16 v[136:151], v[60:63], v[112:119], v1
    v_exp_f32 v122, v122
    v_exp_f32 v123, v123
    v_exp_f32 v124, v124
    v_mfma_f32_32x32x16_bf16 v[104:119], v[24:27], v[4:7], v[152:167]
    v_exp_f32 v125, v125
    v_exp_f32 v126, v126
    v_exp_f32 v127, v127
    v_exp_f32 v128, v128
    v_exp_f32 v129, v129
    v_exp_f32 v130, v130
    v_smfmac_f32_32x32x32_bf16 v[136:151], v[64:67], v[120:127], v1
    v_exp_f32 v131, v131
    v_exp_f32 v132, v132
    v_exp_f32 v133, v133
    v_exp_f32 v134, v134
    v_exp_f32 v135, v135
    s_setprio 1
    v_exp_f32 v104, v104
    v_exp_f32 v105, v105
    v_smfmac_f32_32x32x32_bf16 v[136:151], v[68:71], v[128:135], v1
    v_exp_f32 v106, v106
    v_exp_f32 v107, v107
    v_exp_f32 v108, v108
    v_mfma_f32_32x32x16_bf16 v[120:135], v[28:31], v[4:7], v[152:167]
    v_exp_f32 v109, v109
    v_exp_f32 v110, v110
    v_exp_f32 v111, v111
    v_exp_f32 v112, v112
    v_exp_f32 v113, v113
    v_exp_f32 v114, v114
    v_smfmac_f32_32x32x32_bf16 v[136:151], v[72:75], v[104:111], v1
    v_exp_f32 v115, v115
    v_exp_f32 v116, v116
    v_exp_f32 v117, v117
    v_exp_f32 v118, v118
    v_exp_f32 v119, v119
    v_exp_f32 v120, v120
    v_exp_f32 v121, v121
    v_smfmac_f32_32x32x32_bf16 v[136:151], v[76:79], v[112:119], v1
    v_exp_f32 v122, v122
    v_exp_f32 v123, v123
    v_exp_f32 v124, v124
    v_mfma_f32_32x32x16_bf16 v[104:119], v[32:35], v[4:7], v[152:167]
    v_exp_f32 v125, v125
    v_exp_f32 v126, v126
    v_exp_f32 v127, v127
    v_exp_f32 v128, v128
    v_exp_f32 v129, v129
    v_exp_f32 v130, v130
    v_smfmac_f32_32x32x32_bf16 v[136:151], v[80:83], v[120:127], v1
    v_exp_f32 v131, v131
    v_exp_f32 v132, v132
    v_exp_f32 v133, v133
    v_exp_f32 v134, v134
    v_exp_f32 v135, v135
    v_exp_f32 v104, v104
    v_exp_f32 v105, v105
    v_smfmac_f32_32x32x32_bf16 v[136:151], v[84:87], v[128:135], v1
    v_exp_f32 v106, v106
    v_lshl_add_u32 v2, v0, 2, s0
    v_add_u32 v3, s0, v0
    v_exp_f32 v107, v107
    v_exp_f32 v108, v108
    v_mfma_f32_32x32x16_bf16 v[120:135], v[36:39], v[4:7], v[152:167]
    v_exp_f32 v109, v109
    ds_read_b128 v[4:7], v2 offset:6144
    ds_read_b32 v3, v3 offset:7168
    v_exp_f32 v110, v110
    v_exp_f32 v111, v111
    v_exp_f32 v112, v112
    v_exp_f32 v113, v113
    v_smfmac_f32_32x32x32_bf16 v[136:151], v[88:91], v[104:111], v1
    v_exp_f32 v114, v114
    v_exp_f32 v115, v115
    v_exp_f32 v116, v116
    v_exp_f32 v117, v117
    s_waitcnt lgkmcnt(0)
    v_mfma_f32_32x32x8_bf16 v[152:167], v[0:1], v[2:3], 0
    v_exp_f32 v118, v118
    v_exp_f32 v119, v119
    v_exp_f32 v120, v120
    v_exp_f32 v121, v121
    v_exp_f32 v122, v122
    v_smfmac_f32_32x32x32_bf16 v[136:151], v[92:95], v[112:119], v1
    v_exp_f32 v123, v123
    v_exp_f32 v124, v124
    v_mfma_f32_32x32x16_bf16 v[104:119], v[8:11], v[4:7], v[152:167]
    v_exp_f32 v125, v125
    v_exp_f32 v126, v126
    v_exp_f32 v127, v127
    v_exp_f32 v128, v128
    v_exp_f32 v129, v129
    v_exp_f32 v130, v130
    v_exp_f32 v131, v131
    v_smfmac_f32_32x32x32_bf16 v[136:151], v[96:99], v[120:127], v1
    v_exp_f32 v132, v132
    v_exp_f32 v133, v133
    v_exp_f32 v134, v134
    v_exp_f32 v135, v135
    v_exp_f32 v104, v104
    v_exp_f32 v105, v105
    v_smfmac_f32_32x32x32_bf16 v[136:151], v[100:103], v[128:135], v1
    v_exp_f32 v106, v106
    v_exp_f32 v107, v107
    v_exp_f32 v108, v108
    v_mfma_f32_32x32x16_bf16 v[120:135], v[12:15], v[4:7], v[152:167]
    v_exp_f32 v109, v109
    v_exp_f32 v110, v110
    v_exp_f32 v111, v111
    v_exp_f32 v112, v112
    v_lshl_add_u32 v2, v0, 2, s55
    v_add_u32 v3, s55, v0
    v_exp_f32 v113, v113
    v_exp_f32 v114, v114
    v_writelane_b32 v136, s49, 63
    ds_write_b128 v2, v[144:147] offset:18432
    v_exp_f32 v115, v115
    ds_write_b128 v2, v[148:151] offset:19456
    v_exp_f32 v116, v116
    ds_write_b32 v3, v136 offset:20480
    v_exp_f32 v117, v117
    v_mov_b32 v136, 0
    v_mov_b64 v[144:145], 0
    v_mov_b64 v[146:147], 0
    v_mov_b64 v[148:149], 0
    v_mov_b64 v[150:151], 0
    v_exp_f32 v118, v118
    v_exp_f32 v119, v119
    v_smfmac_f32_32x32x32_bf16 v[136:151], v[40:43], v[104:111], v1
    v_exp_f32 v120, v120
    v_exp_f32 v121, v121
    v_exp_f32 v122, v122
    v_smfmac_f32_32x32x32_bf16 v[136:151], v[44:47], v[112:119], v1
    v_exp_f32 v123, v123
    v_exp_f32 v124, v124
    v_mfma_f32_32x32x16_bf16 v[104:119], v[16:19], v[4:7], v[152:167]
    v_exp_f32 v125, v125
    v_exp_f32 v126, v126
    v_exp_f32 v127, v127
    v_exp_f32 v128, v128
    v_exp_f32 v129, v129
    v_exp_f32 v130, v130
    v_exp_f32 v131, v131
    v_smfmac_f32_32x32x32_bf16 v[136:151], v[48:51], v[120:127], v1
    v_exp_f32 v132, v132
    v_exp_f32 v133, v133
    v_exp_f32 v134, v134
    v_exp_f32 v135, v135
    v_exp_f32 v104, v104
    v_exp_f32 v105, v105
    v_smfmac_f32_32x32x32_bf16 v[136:151], v[52:55], v[128:135], v1
    v_exp_f32 v106, v106
    v_exp_f32 v107, v107
    v_exp_f32 v108, v108
    v_mfma_f32_32x32x16_bf16 v[120:135], v[20:23], v[4:7], v[152:167]
    v_exp_f32 v109, v109
    v_exp_f32 v110, v110
    v_exp_f32 v111, v111
    v_exp_f32 v112, v112
    v_exp_f32 v113, v113
    v_exp_f32 v114, v114
    v_smfmac_f32_32x32x32_bf16 v[136:151], v[56:59], v[104:111], v1
    v_exp_f32 v115, v115
    v_exp_f32 v116, v116
    v_exp_f32 v117, v117
    v_exp_f32 v118, v118
    v_exp_f32 v119, v119
    s_setprio 0
    v_exp_f32 v120, v120
    v_exp_f32 v121, v121
    v_smfmac_f32_32x32x32_bf16 v[136:151], v[60:63], v[112:119], v1
    v_exp_f32 v122, v122
    v_exp_f32 v123, v123
    v_exp_f32 v124, v124
    v_mfma_f32_32x32x16_bf16 v[104:119], v[24:27], v[4:7], v[152:167]
    v_exp_f32 v125, v125
    v_exp_f32 v126, v126
    v_exp_f32 v127, v127
    v_exp_f32 v128, v128
    v_exp_f32 v129, v129
    v_exp_f32 v130, v130
    v_smfmac_f32_32x32x32_bf16 v[136:151], v[64:67], v[120:127], v1
    v_exp_f32 v131, v131
    v_exp_f32 v132, v132
    v_exp_f32 v133, v133
    v_exp_f32 v134, v134
    v_exp_f32 v135, v135
    v_exp_f32 v104, v104
    v_exp_f32 v105, v105
    v_smfmac_f32_32x32x32_bf16 v[136:151], v[68:71], v[128:135], v1
    v_exp_f32 v106, v106
    v_exp_f32 v107, v107
    v_exp_f32 v108, v108
    v_mfma_f32_32x32x16_bf16 v[120:135], v[28:31], v[4:7], v[152:167]
    v_exp_f32 v109, v109
    v_exp_f32 v110, v110
    v_exp_f32 v111, v111
    v_exp_f32 v112, v112
    v_exp_f32 v113, v113
    v_exp_f32 v114, v114
    v_smfmac_f32_32x32x32_bf16 v[136:151], v[72:75], v[104:111], v1
    v_exp_f32 v115, v115
    v_exp_f32 v116, v116
    v_exp_f32 v117, v117
    v_exp_f32 v118, v118
    v_exp_f32 v119, v119
    s_setprio 2
    v_exp_f32 v120, v120
    v_exp_f32 v121, v121
    v_smfmac_f32_32x32x32_bf16 v[136:151], v[76:79], v[112:119], v1
    v_exp_f32 v122, v122
    v_exp_f32 v123, v123
    v_exp_f32 v124, v124
    v_mfma_f32_32x32x16_bf16 v[104:119], v[32:35], v[4:7], v[152:167]
    v_exp_f32 v125, v125
    v_exp_f32 v126, v126
    v_exp_f32 v127, v127
    v_exp_f32 v128, v128
    v_exp_f32 v129, v129
    v_exp_f32 v130, v130
    v_smfmac_f32_32x32x32_bf16 v[136:151], v[80:83], v[120:127], v1
    v_exp_f32 v131, v131
    v_exp_f32 v132, v132
    v_exp_f32 v133, v133
    v_exp_f32 v134, v134
    v_exp_f32 v135, v135
    v_exp_f32 v104, v104
    v_exp_f32 v105, v105
    v_smfmac_f32_32x32x32_bf16 v[136:151], v[84:87], v[128:135], v1
    v_exp_f32 v106, v106
    v_lshl_add_u32 v2, v0, 2, s0
    v_add_u32 v3, s0, v0
    v_exp_f32 v107, v107
    v_exp_f32 v108, v108
    v_mfma_f32_32x32x16_bf16 v[120:135], v[36:39], v[4:7], v[152:167]
    v_exp_f32 v109, v109
    ds_read_b128 v[4:7], v2 offset:9216
    ds_read_b32 v3, v3 offset:10240
    v_exp_f32 v110, v110
    v_exp_f32 v111, v111
    v_exp_f32 v112, v112
    v_exp_f32 v113, v113
    v_smfmac_f32_32x32x32_bf16 v[136:151], v[88:91], v[104:111], v1
    v_exp_f32 v114, v114
    v_exp_f32 v115, v115
    v_exp_f32 v116, v116
    v_exp_f32 v117, v117
    s_waitcnt lgkmcnt(0)
    v_mfma_f32_32x32x8_bf16 v[152:167], v[0:1], v[2:3], 0
    v_exp_f32 v118, v118
    v_exp_f32 v119, v119
    v_exp_f32 v120, v120
    v_exp_f32 v121, v121
    v_exp_f32 v122, v122
    v_smfmac_f32_32x32x32_bf16 v[136:151], v[92:95], v[112:119], v1
    v_exp_f32 v123, v123
    v_exp_f32 v124, v124
    v_mfma_f32_32x32x16_bf16 v[104:119], v[8:11], v[4:7], v[152:167]
    v_exp_f32 v125, v125
    v_exp_f32 v126, v126
    v_mov_b32 v2, s54
    ds_read_b32 v3, v2 offset:2300
    v_exp_f32 v127, v127
    v_exp_f32 v128, v128
    v_exp_f32 v129, v129
    v_exp_f32 v130, v130
    v_exp_f32 v131, v131
    v_smfmac_f32_32x32x32_bf16 v[136:151], v[96:99], v[120:127], v1
    v_exp_f32 v132, v132
    v_exp_f32 v133, v133
    v_exp_f32 v134, v134
    v_exp_f32 v135, v135
    s_waitcnt lgkmcnt(0)
L_grd4:
    v_readfirstlane_b32 s57, v3
    s_nop 0
    s_cmp_lg_u32 s57, s52
    s_cbranch_scc1 L_gw4
L_gok4:
    v_exp_f32 v104, v104
    v_exp_f32 v105, v105
    v_smfmac_f32_32x32x32_bf16 v[136:151], v[100:103], v[128:135], v1
    v_exp_f32 v106, v106
    v_exp_f32 v107, v107
    v_exp_f32 v108, v108
    v_mfma_f32_32x32x16_bf16 v[120:135], v[12:15], v[4:7], v[152:167]
    v_exp_f32 v109, v109
    v_exp_f32 v110, v110
    v_exp_f32 v111, v111
    v_exp_f32 v112, v112
    v_lshl_add_u32 v2, v0, 2, s54
    v_add_u32 v3, s54, v0
    v_exp_f32 v113, v113
    v_exp_f32 v114, v114
    v_writelane_b32 v136, s50, 63
    ds_write_b128 v2, v[144:147] offset:0
    v_exp_f32 v115, v115
    ds_write_b128 v2, v[148:151] offset:1024
    v_exp_f32 v116, v116
    ds_write_b32 v3, v136 offset:2048
    v_exp_f32 v117, v117
    v_mov_b32 v136, 0
    v_mov_b64 v[144:145], 0
    v_mov_b64 v[146:147], 0
    v_mov_b64 v[148:149], 0
    v_mov_b64 v[150:151], 0
    v_exp_f32 v118, v118
    v_exp_f32 v119, v119
    v_smfmac_f32_32x32x32_bf16 v[136:151], v[40:43], v[104:111], v1
    v_exp_f32 v120, v120
    v_exp_f32 v121, v121
    v_exp_f32 v122, v122
    v_smfmac_f32_32x32x32_bf16 v[136:151], v[44:47], v[112:119], v1
    v_exp_f32 v123, v123
    v_exp_f32 v124, v124
    v_mfma_f32_32x32x16_bf16 v[104:119], v[16:19], v[4:7], v[152:167]
    v_exp_f32 v125, v125
    v_exp_f32 v126, v126
    v_exp_f32 v127, v127
    v_exp_f32 v128, v128
    v_exp_f32 v129, v129
    v_exp_f32 v130, v130
    v_exp_f32 v131, v131
    v_smfmac_f32_32x32x32_bf16 v[136:151], v[48:51], v[120:127], v1
    v_exp_f32 v132, v132
    v_exp_f32 v133, v133
    v_exp_f32 v134, v134
    v_exp_f32 v135, v135
    v_exp_f32 v104, v104
    v_exp_f32 v105, v105
    v_smfmac_f32_32x32x32_bf16 v[136:151], v[52:55], v[128:135], v1
    v_exp_f32 v106, v106
    v_exp_f32 v107, v107
    v_exp_f32 v108, v108
    v_mfma_f32_32x32x16_bf16 v[120:135], v[20:23], v[4:7], v[152:167]
    v_exp_f32 v109, v109
    v_exp_f32 v110, v110
    v_exp_f32 v111, v111
    v_exp_f32 v112, v112
    v_exp_f32 v113, v113
    v_exp_f32 v114, v114
    v_smfmac_f32_32x32x32_bf16 v[136:151], v[56:59], v[104:111], v1
    v_exp_f32 v115, v115
    v_exp_f32 v116, v116
    v_exp_f32 v117, v117
    v_exp_f32 v118, v118
    v_exp_f32 v119, v119
    v_exp_f32 v120, v120
    v_exp_f32 v121, v121
    v_smfmac_f32_32x32x32_bf16 v[136:151], v[60:63], v[112:119], v1
    v_exp_f32 v122, v122
    v_exp_f32 v123, v123
    v_exp_f32 v124, v124
    v_mfma_f32_32x32x16_bf16 v[104:119], v[24:27], v[4:7], v[152:167]
    v_exp_f32 v125, v125
    v_exp_f32 v126, v126
    v_exp_f32 v127, v127
    v_exp_f32 v128, v128
    v_exp_f32 v129, v129
    v_exp_f32 v130, v130
    v_smfmac_f32_32x32x32_bf16 v[136:151], v[64:67], v[120:127], v1
    v_exp_f32 v131, v131
    v_exp_f32 v132, v132
    v_exp_f32 v133, v133
    v_exp_f32 v134, v134
    v_exp_f32 v135, v135
    v_exp_f32 v104, v104
    v_exp_f32 v105, v105
    v_smfmac_f32_32x32x32_bf16 v[136:151], v[68:71], v[128:135], v1
    v_exp_f32 v106, v106
    v_exp_f32 v107, v107
    v_exp_f32 v108, v108
    v_mfma_f32_32x32x16_bf16 v[120:135], v[28:31], v[4:7], v[152:167]
    v_exp_f32 v109, v109
    v_exp_f32 v110, v110
    v_exp_f32 v111, v111
    v_exp_f32 v112, v112
    v_exp_f32 v113, v113
    v_exp_f32 v114, v114
    v_smfmac_f32_32x32x32_bf16 v[136:151], v[72:75], v[104:111], v1
    v_exp_f32 v115, v115
    v_exp_f32 v116, v116
    v_exp_f32 v117, v117
    v_exp_f32 v118, v118
    v_exp_f32 v119, v119
    v_exp_f32 v120, v120
    v_exp_f32 v121, v121
    v_smfmac_f32_32x32x32_bf16 v[136:151], v[76:79], v[112:119], v1
    v_exp_f32 v122, v122
    v_exp_f32 v123, v123
    v_exp_f32 v124, v124
    v_mfma_f32_32x32x16_bf16 v[104:119], v[32:35], v[4:7], v[152:167]
    v_exp_f32 v125, v125
    v_exp_f32 v126, v126
    v_exp_f32 v127, v127
    v_exp_f32 v128, v128
    v_exp_f32 v129, v129
    v_exp_f32 v130, v130
    v_smfmac_f32_32x32x32_bf16 v[136:151], v[80:83], v[120:127], v1
    v_exp_f32 v131, v131
    v_exp_f32 v132, v132
    v_exp_f32 v133, v133
    v_exp_f32 v134, v134
    v_exp_f32 v135, v135
    v_exp_f32 v104, v104
    v_exp_f32 v105, v105
    v_smfmac_f32_32x32x32_bf16 v[136:151], v[84:87], v[128:135], v1
    v_exp_f32 v106, v106
    v_lshl_add_u32 v2, v0, 2, s1
    v_add_u32 v3, s1, v0
    v_exp_f32 v107, v107
    v_exp_f32 v108, v108
    v_mfma_f32_32x32x16_bf16 v[120:135], v[36:39], v[4:7], v[152:167]
    v_exp_f32 v109, v109
    ds_read_b128 v[4:7], v2 offset:6144
    ds_read_b32 v3, v3 offset:7168
    v_exp_f32 v110, v110
    v_exp_f32 v111, v111
    v_exp_f32 v112, v112
    v_exp_f32 v113, v113
    v_smfmac_f32_32x32x32_bf16 v[136:151], v[88:91], v[104:111], v1
    v_exp_f32 v114, v114
    v_exp_f32 v115, v115
    v_exp_f32 v116, v116
    v_exp_f32 v117, v117
    s_waitcnt lgkmcnt(0)
    v_mfma_f32_32x32x8_bf16 v[152:167], v[0:1], v[2:3], 0
    v_exp_f32 v118, v118
    v_exp_f32 v119, v119
    s_setprio 1
    v_exp_f32 v120, v120
    v_exp_f32 v121, v121
    v_exp_f32 v122, v122
    v_smfmac_f32_32x32x32_bf16 v[136:151], v[92:95], v[112:119], v1
    v_exp_f32 v123, v123
    v_exp_f32 v124, v124
    v_mfma_f32_32x32x16_bf16 v[104:119], v[8:11], v[4:7], v[152:167]
    v_exp_f32 v125, v125
    v_exp_f32 v126, v126
    v_mov_b32 v2, s54
    ds_read_b32 v3, v2 offset:20732
    v_exp_f32 v127, v127
    v_exp_f32 v128, v128
    v_exp_f32 v129, v129
    v_exp_f32 v130, v130
    v_exp_f32 v131, v131
    v_smfmac_f32_32x32x32_bf16 v[136:151], v[96:99], v[120:127], v1
    v_exp_f32 v132, v132
    v_exp_f32 v133, v133
    v_exp_f32 v134, v134
    v_exp_f32 v135, v135
    s_waitcnt lgkmcnt(0)
L_grd5:
    v_readfirstlane_b32 s57, v3
    s_nop 0
    s_cmp_lg_u32 s57, s52
    s_cbranch_scc1 L_gw5
L_gok5:
    v_exp_f32 v104, v104
    v_exp_f32 v105, v105
    v_smfmac_f32_32x32x32_bf16 v[136:151], v[100:103], v[128:135], v1
    v_exp_f32 v106, v106
    v_exp_f32 v107, v107
    v_exp_f32 v108, v108
    v_mfma_f32_32x32x16_bf16 v[120:135], v[12:15], v[4:7], v[152:167]
    v_exp_f32 v109, v109
    v_exp_f32 v110, v110
    v_exp_f32 v111, v111
    v_exp_f32 v112, v112
    v_lshl_add_u32 v2, v0, 2, s54
    v_add_u32 v3, s54, v0
    v_exp_f32 v113, v113
    v_exp_f32 v114, v114
    v_writelane_b32 v136, s50, 63
    ds_write_b128 v2, v[144:147] offset:18432
    ds_write_b128 v2, v[148:151] offset:19456
    ds_write_b32 v3, v136 offset:20480
    v_lshl_add_u32 v2, v0, 2, s55
    v_add_u32 v3, s55, v0
    ds_read_b32 v136, v3 offset:2048
    ds_read_b128 v[144:147], v2 offset:0
    ds_read_b128 v[148:151], v2 offset:1024
    v_exp_f32 v115, v115
    v_exp_f32 v116, v116
    v_exp_f32 v117, v117
    v_exp_f32 v118, v118
    v_exp_f32 v119, v119
L_got6:
    s_waitcnt lgkmcnt(0)
    v_readlane_b32 s57, v136, 63
    s_nop 0
    s_cmp_lg_u32 s57, s50
    s_cbranch_scc1 L_wait6
L_go6:
    v_smfmac_f32_32x32x32_bf16 v[136:151], v[40:43], v[104:111], v1
    v_exp_f32 v120, v120
    v_exp_f32 v121, v121
    v_exp_f32 v122, v122
    v_smfmac_f32_32x32x32_bf16 v[136:151], v[44:47], v[112:119], v1
    v_exp_f32 v123, v123
    v_exp_f32 v124, v124
    v_mfma_f32_32x32x16_bf16 v[104:119], v[16:19], v[4:7], v[152:167]
    v_exp_f32 v125, v125
    v_exp_f32 v126, v126
    v_exp_f32 v127, v127
    v_exp_f32 v128, v128
    v_exp_f32 v129, v129
    v_exp_f32 v130, v130
    v_exp_f32 v131, v131
    v_smfmac_f32_32x32x32_bf16 v[136:151], v[48:51], v[120:127], v1
    v_exp_f32 v132, v132
    v_exp_f32 v133, v133
    v_exp_f32 v134, v134
    v_exp_f32 v135, v135
    s_sub_u32 s57, s3, 3
    s_cmp_lt_u32 s57, 2
    s_cbranch_scc0 nt_12
    v_lshlrev_b32 v3, s47, v0
    s_mov_b32 exec_hi, 0x7ff
    buffer_load_dword v3, s[36:39], s46 offen lds
    s_mov_b32 exec_hi, -1
nt_12:
    v_exp_f32 v104, v104
    v_exp_f32 v105, v105
    v_smfmac_f32_32x32x32_bf16 v[136:151], v[52:55], v[128:135], v1
    v_exp_f32 v106, v106
    v_exp_f32 v107, v107
    v_exp_f32 v108, v108
    v_mfma_f32_32x32x16_bf16 v[120:135], v[20:23], v[4:7], v[152:167]
    v_exp_f32 v109, v109
    v_exp_f32 v110, v110
    v_exp_f32 v111, v111
    v_exp_f32 v112, v112
    v_exp_f32 v113, v113
    v_exp_f32 v114, v114
    v_smfmac_f32_32x32x32_bf16 v[136:151], v[56:59], v[104:111], v1
    v_exp_f32 v115, v115
    v_exp_f32 v116, v116
    v_exp_f32 v117, v117
    v_exp_f32 v118, v118
    v_exp_f32 v119, v119
    v_exp_f32 v120, v120
    v_exp_f32 v121, v121
    v_smfmac_f32_32x32x32_bf16 v[136:151], v[60:63], v[112:119], v1
    v_exp_f32 v122, v122
    v_exp_f32 v123, v123
    v_exp_f32 v124, v124
    v_mfma_f32_32x32x16_bf16 v[104:119], v[24:27], v[4:7], v[152:167]
    v_exp_f32 v125, v125
    v_exp_f32 v126, v126
    v_exp_f32 v127, v127
    v_exp_f32 v128, v128
    v_exp_f32 v129, v129
    v_exp_f32 v130, v130
    v_smfmac_f32_32x32x32_bf16 v[136:151], v[64:67], v[120:127], v1
    v_exp_f32 v131, v131
    v_exp_f32 v132, v132
    v_exp_f32 v133, v133
    v_exp_f32 v134, v134
    v_exp_f32 v135, v135
    v_exp_f32 v104, v104
    v_exp_f32 v105, v105
    v_smfmac_f32_32x32x32_bf16 v[136:151], v[68:71], v[128:135], v1
    v_exp_f32 v106, v106
    v_exp_f32 v107, v107
    v_exp_f32 v108, v108
    v_mfma_f32_32x32x16_bf16 v[120:135], v[28:31], v[4:7], v[152:167]
    v_exp_f32 v109, v109
    v_exp_f32 v110, v110
    v_exp_f32 v111, v111
    v_exp_f32 v112, v112
    v_exp_f32 v113, v113
    v_exp_f32 v114, v114
    v_smfmac_f32_32x32x32_bf16 v[136:151], v[72:75], v[104:111], v1
    v_exp_f32 v115, v115
    v_exp_f32 v116, v116
    v_exp_f32 v117, v117
    v_exp_f32 v118, v118
    v_exp_f32 v119, v119
    v_exp_f32 v120, v120
    v_exp_f32 v121, v121
    v_smfmac_f32_32x32x32_bf16 v[136:151], v[76:79], v[112:119], v1
    v_exp_f32 v122, v122
    v_exp_f32 v123, v123
    v_exp_f32 v124, v124
    v_mfma_f32_32x32x16_bf16 v[104:119], v[32:35], v[4:7], v[152:167]
    v_exp_f32 v125, v125
    v_exp_f32 v126, v126
    v_exp_f32 v127, v127
    v_exp_f32 v128, v128
    v_exp_f32 v129, v129
    v_exp_f32 v130, v130
    v_smfmac_f32_32x32x32_bf16 v[136:151], v[80:83], v[120:127], v1
    v_exp_f32 v131, v131
    v_exp_f32 v132, v132
    v_exp_f32 v133, v133
    v_exp_f32 v134, v134
    v_exp_f32 v135, v135
    v_exp_f32 v104, v104
    v_exp_f32 v105, v105
    v_smfmac_f32_32x32x32_bf16 v[136:151], v[84:87], v[128:135], v1
    v_exp_f32 v106, v106
    v_lshl_add_u32 v2, v0, 2, s1
    v_add_u32 v3, s1, v0
    v_exp_f32 v107, v107
    v_exp_f32 v108, v108
    v_mfma_f32_32x32x16_bf16 v[120:135], v[36:39], v[4:7], v[152:167]
    v_exp_f32 v109, v109
    ds_read_b128 v[4:7], v2 offset:9216
    ds_read_b32 v3, v3 offset:10240
    v_exp_f32 v110, v110
    v_exp_f32 v111, v111
    v_exp_f32 v112, v112
    v_exp_f32 v113, v113
    v_smfmac_f32_32x32x32_bf16 v[136:151], v[88:91], v[104:111], v1
    v_exp_f32 v114, v114
    v_exp_f32 v115, v115
    v_exp_f32 v116, v116
    v_exp_f32 v117, v117
    s_waitcnt lgkmcnt(0)
    v_mfma_f32_32x32x8_bf16 v[152:167], v[0:1], v[2:3], 0
    v_exp_f32 v118, v118
    v_exp_f32 v119, v119
    v_exp_f32 v120, v120
    v_exp_f32 v121, v121
    v_exp_f32 v122, v122
    v_smfmac_f32_32x32x32_bf16 v[136:151], v[92:95], v[112:119], v1
    v_exp_f32 v123, v123
    v_exp_f32 v124, v124
    v_mfma_f32_32x32x16_bf16 v[104:119], v[8:11], v[4:7], v[152:167]
    v_exp_f32 v125, v125
    v_exp_f32 v126, v126
    v_exp_f32 v127, v127
    v_exp_f32 v128, v128
    v_exp_f32 v129, v129
    v_exp_f32 v130, v130
    v_exp_f32 v131, v131
    v_smfmac_f32_32x32x32_bf16 v[136:151], v[96:99], v[120:127], v1
    v_exp_f32 v132, v132
    v_exp_f32 v133, v133
    v_exp_f32 v134, v134
    v_exp_f32 v135, v135
    v_exp_f32 v104, v104
    v_exp_f32 v105, v105
    v_smfmac_f32_32x32x32_bf16 v[136:151], v[100:103], v[128:135], v1
    v_exp_f32 v106, v106
    v_exp_f32 v107, v107
    v_exp_f32 v108, v108
    v_mfma_f32_32x32x16_bf16 v[120:135], v[12:15], v[4:7], v[152:167]
    v_exp_f32 v109, v109
    v_exp_f32 v110, v110
    v_exp_f32 v111, v111
    v_exp_f32 v112, v112
    v_lshl_add_u32 v2, v0, 2, s55
    v_add_u32 v3, s55, v0
    v_exp_f32 v113, v113
    v_exp_f32 v114, v114
    v_writelane_b32 v136, s51, 63
    ds_write_b128 v2, v[144:147] offset:0
    ds_write_b128 v2, v[148:151] offset:1024
    ds_write_b32 v3, v136 offset:2048
    ds_read_b32 v136, v3 offset:20480
    ds_read_b128 v[144:147], v2 offset:18432
    ds_read_b128 v[148:151], v2 offset:19456
    v_exp_f32 v115, v115
    v_exp_f32 v116, v116
    v_exp_f32 v117, v117
    v_exp_f32 v118, v118
    v_exp_f32 v119, v119
L_got7:
    s_waitcnt lgkmcnt(0)
    v_readlane_b32 s57, v136, 63
    s_nop 0
    s_cmp_lg_u32 s57, s50
    s_cbranch_scc1 L_wait7
L_go7:
    v_smfmac_f32_32x32x32_bf16 v[136:151], v[40:43], v[104:111], v1
    s_setprio 0
    v_exp_f32 v120, v120
    v_exp_f32 v121, v121
    v_exp_f32 v122, v122
    v_smfmac_f32_32x32x32_bf16 v[136:151], v[44:47], v[112:119], v1
    v_exp_f32 v123, v123
    v_exp_f32 v124, v124
    v_mfma_f32_32x32x16_bf16 v[104:119], v[16:19], v[4:7], v[152:167]
    v_exp_f32 v125, v125
    v_exp_f32 v126, v126
    v_exp_f32 v127, v127
    v_exp_f32 v128, v128
    v_exp_f32 v129, v129
    v_exp_f32 v130, v130
    v_exp_f32 v131, v131
    v_smfmac_f32_32x32x32_bf16 v[136:151], v[48:51], v[120:127], v1
    v_exp_f32 v132, v132
    v_exp_f32 v133, v133
    v_exp_f32 v134, v134
    v_exp_f32 v135, v135
    v_exp_f32 v104, v104
    v_exp_f32 v105, v105
    v_smfmac_f32_32x32x32_bf16 v[136:151], v[52:55], v[128:135], v1
    v_exp_f32 v106, v106
    v_exp_f32 v107, v107
    v_exp_f32 v108, v108
    v_mfma_f32_32x32x16_bf16 v[120:135], v[20:23], v[4:7], v[152:167]
    v_exp_f32 v109, v109
    v_exp_f32 v110, v110
    v_exp_f32 v111, v111
    v_exp_f32 v112, v112
    v_exp_f32 v113, v113
    v_exp_f32 v114, v114
    v_smfmac_f32_32x32x32_bf16 v[136:151], v[56:59], v[104:111], v1
    v_exp_f32 v115, v115
    v_exp_f32 v116, v116
    v_exp_f32 v117, v117
    v_exp_f32 v118, v118
    v_exp_f32 v119, v119
    v_exp_f32 v120, v120
    v_exp_f32 v121, v121
    v_smfmac_f32_32x32x32_bf16 v[136:151], v[60:63], v[112:119], v1
    v_exp_f32 v122, v122
    v_exp_f32 v123, v123
    v_exp_f32 v124, v124
    v_mfma_f32_32x32x16_bf16 v[104:119], v[24:27], v[4:7], v[152:167]
    v_exp_f32 v125, v125
    v_exp_f32 v126, v126
    v_exp_f32 v127, v127
    v_exp_f32 v128, v128
    v_exp_f32 v129, v129
    v_exp_f32 v130, v130
    v_smfmac_f32_32x32x32_bf16 v[136:151], v[64:67], v[120:127], v1
    v_exp_f32 v131, v131
    v_exp_f32 v132, v132
    v_exp_f32 v133, v133
    v_exp_f32 v134, v134
    v_exp_f32 v135, v135
    v_exp_f32 v104, v104
    v_exp_f32 v105, v105
    v_smfmac_f32_32x32x32_bf16 v[136:151], v[68:71], v[128:135], v1
    v_exp_f32 v106, v106
    v_exp_f32 v107, v107
    v_exp_f32 v108, v108
    v_mfma_f32_32x32x16_bf16 v[120:135], v[28:31], v[4:7], v[152:167]
    v_exp_f32 v109, v109
    v_exp_f32 v110, v110
    v_exp_f32 v111, v111
    v_exp_f32 v112, v112
    v_exp_f32 v113, v113
    v_exp_f32 v114, v114
    v_smfmac_f32_32x32x32_bf16 v[136:151], v[72:75], v[104:111], v1
    v_exp_f32 v115, v115
    v_exp_f32 v116, v116
    v_exp_f32 v117, v117
    v_exp_f32 v118, v118
    v_exp_f32 v119, v119
    v_exp_f32 v120, v120
    v_exp_f32 v121, v121
    v_smfmac_f32_32x32x32_bf16 v[136:151], v[76:79], v[112:119], v1
    v_exp_f32 v122, v122
    v_exp_f32 v123, v123
    v_exp_f32 v124, v124
    v_mfma_f32_32x32x16_bf16 v[104:119], v[32:35], v[4:7], v[152:167]
    v_exp_f32 v125, v125
    v_exp_f32 v126, v126
    v_exp_f32 v127, v127
    v_exp_f32 v128, v128
    v_exp_f32 v129, v129
    v_exp_f32 v130, v130
    v_smfmac_f32_32x32x32_bf16 v[136:151], v[80:83], v[120:127], v1
    v_exp_f32 v131, v131
    v_exp_f32 v132, v132
    v_exp_f32 v133, v133
    v_exp_f32 v134, v134
    v_exp_f32 v135, v135
    v_exp_f32 v104, v104
    v_exp_f32 v105, v105
    v_smfmac_f32_32x32x32_bf16 v[136:151], v[84:87], v[128:135], v1
    v_exp_f32 v106, v106
    v_exp_f32 v107, v107
    v_exp_f32 v108, v108
    v_mfma_f32_32x32x16_bf16 v[120:135], v[36:39], v[4:7], v[152:167]
    v_exp_f32 v109, v109
    v_exp_f32 v110, v110
    v_exp_f32 v111, v111
    v_exp_f32 v112, v112
    v_exp_f32 v113, v113
    v_exp_f32 v114, v114
    v_smfmac_f32_32x32x32_bf16 v[136:151], v[88:91], v[104:111], v1
    v_exp_f32 v115, v115
    v_exp_f32 v116, v116
    v_exp_f32 v117, v117
    v_exp_f32 v118, v118
    v_exp_f32 v119, v119
    v_exp_f32 v120, v120
    v_exp_f32 v121, v121
    v_smfmac_f32_32x32x32_bf16 v[136:151], v[92:95], v[112:119], v1
    v_exp_f32 v122, v122
    v_exp_f32 v123, v123
    v_exp_f32 v124, v124
    v_exp_f32 v125, v125
    v_exp_f32 v126, v126
    v_exp_f32 v127, v127
    v_exp_f32 v128, v128
    v_exp_f32 v129, v129
    v_exp_f32 v130, v130
    v_smfmac_f32_32x32x32_bf16 v[136:151], v[96:99], v[120:127], v1
    v_exp_f32 v131, v131
    v_exp_f32 v132, v132
    v_exp_f32 v133, v133
    v_exp_f32 v134, v134
    v_exp_f32 v135, v135
    s_setprio 2
    s_nop 0
    v_smfmac_f32_32x32x32_bf16 v[136:151], v[100:103], v[128:135], v1
    v_mov_b32 v21, 152832
    ds_read_b32 v20, v21 offset:48
    s_lshl_b32 s57, s3, 2
    s_lshr_b32 s10, 8451, s57
    s_and_b32 s10, s10, 3
    s_mul_i32 s57, s10, 9216
    s_add_u32 s57, s57, 114688
    v_bfe_u32 v16, v0, 2, 2
    v_mul_u32_u24 v16, 2304, v16
    v_add_u32 v16, s57, v16
    v_lshl_add_u32 v2, v0, 2, s55
    v_add_u32 v3, s55, v0
    v_writelane_b32 v136, s51, 63
    ds_write_b128 v2, v[144:147] offset:18432
    ds_write_b128 v2, v[148:151] offset:19456
    ds_write_b32 v3, v136 offset:20480
    s_cmp_ge_u32 s3, 4
    s_cbranch_scc1 L_aend
    ds_read_b32 v19, v16 offset:2300
    v_lshlrev_b32 v2, 2, v0
    v_and_b32 v18, 0x7f, v0
    v_add_u32 v17, s57, v2
    v_add_u32 v18, s57, v18
    s_add_u32 s10, s10, 4
    s_mov_b32 s11, s10
    s_add_u32 s24, s52, 4
    s_mov_b32 s0, 4
    s_mov_b32 s20, 0
    s_mov_b32 s23, 0
    s_mov_b32 s36, s32
    s_mov_b32 s37, s33
    s_mov_b32 s38, 0
    s_mov_b32 s39, 0x20000
    s_mov_b32 s44, s32
    s_mov_b32 s45, s33
    s_mov_b32 s46, 0
    s_mov_b32 s47, 0x20000
    s_mov_b32 s48, s32
    s_mov_b32 s49, s33
    s_mov_b32 s50, 0
    s_mov_b32 s51, 0x20000
    s_waitcnt lgkmcnt(1)
    v_readfirstlane_b32 s25, v20
    v_readfirstlane_b32 s30, v20
    s_branch L_ownw
L_aend:
    s_endpgm
L_wait2:
    s_add_u32 s63, s63, 1
    s_cmp_gt_u32 s63, 131072
    s_cbranch_scc1 L_go2
    s_sleep 2
    ds_read_b32 v136, v3 offset:2048
    ds_read_b128 v[144:147], v2 offset:0
    ds_read_b128 v[148:151], v2 offset:1024
    s_branch L_got2
L_wait3:
    s_add_u32 s63, s63, 1
    s_cmp_gt_u32 s63, 131072
    s_cbranch_scc1 L_go3
    s_sleep 2
    ds_read_b32 v136, v3 offset:20480
    ds_read_b128 v[144:147], v2 offset:18432
    ds_read_b128 v[148:151], v2 offset:19456
    s_branch L_got3
L_gw4:
    s_add_u32 s63, s63, 1
    s_cmp_gt_u32 s63, 131072
    s_cbranch_scc1 L_gok4
    s_sleep 2
    ds_read_b32 v3, v2 offset:2300
    s_waitcnt lgkmcnt(0)
    s_branch L_grd4
L_gw5:
    s_add_u32 s63, s63, 1
    s_cmp_gt_u32 s63, 131072
    s_cbranch_scc1 L_gok5
    s_sleep 2
    ds_read_b32 v3, v2 offset:20732
    s_waitcnt lgkmcnt(0)
    s_branch L_grd5
L_wait6:
    s_add_u32 s63, s63, 1
    s_cmp_gt_u32 s63, 131072
    s_cbranch_scc1 L_go6
    s_sleep 2
    ds_read_b32 v136, v3 offset:2048
    ds_read_b128 v[144:147], v2 offset:0
    ds_read_b128 v[148:151], v2 offset:1024
    s_branch L_got6
L_wait7:
    s_add_u32 s63, s63, 1
    s_cmp_gt_u32 s63, 131072
    s_cbranch_scc1 L_go7
    s_sleep 2
    ds_read_b32 v136, v3 offset:20480
    ds_read_b128 v[144:147], v2 offset:18432
    ds_read_b128 v[148:151], v2 offset:19456
    s_branch L_got7
L_vs0:
.p2align 6
L_gwave:
    s_setprio 3
    s_sub_u32 s54, s3, 8
    v_lshlrev_b32 v2, 4, v0
    v_lshlrev_b32 v10, 7, v0
    s_sub_u32 s61, s54, 1
    s_waitcnt lgkmcnt(0)
    s_cmp_lg_u32 s54, 0
    s_cbranch_scc1 L_g123
    s_cmp_eq_u32 s7, 0
    s_cselect_b32 s44, s12, s14
    s_cselect_b32 s45, s13, s15
    s_mov_b32 s46, 16384
    s_mov_b32 s47, 0x20000
    s_mov_b32 m0, 131072
    s_mov_b32 s57, 0
    buffer_load_dwordx4 v2, s[44:47], s57 offen offset:0 lds
    buffer_load_dwordx4 v2, s[44:47], s57 offen offset:1024 lds
    buffer_load_dwordx4 v2, s[44:47], s57 offen offset:2048 lds
    buffer_load_dwordx4 v2, s[44:47], s57 offen offset:3072 lds
    s_mov_b32 m0, 135168
    s_mov_b32 s57, 4096
    buffer_load_dwordx4 v2, s[44:47], s57 offen offset:0 lds
    buffer_load_dwordx4 v2, s[44:47], s57 offen offset:1024 lds
    buffer_load_dwordx4 v2, s[44:47], s57 offen offset:2048 lds
    buffer_load_dwordx4 v2, s[44:47], s57 offen offset:3072 lds
    s_mov_b32 m0, 139264
    s_mov_b32 s57, 8192
    buffer_load_dwordx4 v2, s[44:47], s57 offen offset:0 lds
    buffer_load_dwordx4 v2, s[44:47], s57 offen offset:1024 lds
    buffer_load_dwordx4 v2, s[44:47], s57 offen offset:2048 lds
    buffer_load_dwordx4 v2, s[44:47], s57 offen offset:3072 lds
    s_mov_b32 m0, 143360
    s_mov_b32 s57, 12288
    buffer_load_dwordx4 v2, s[44:47], s57 offen offset:0 lds
    buffer_load_dwordx4 v2, s[44:47], s57 offen offset:1024 lds
    buffer_load_dwordx4 v2, s[44:47], s57 offen offset:2048 lds
    buffer_load_dwordx4 v2, s[44:47], s57 offen offset:3072 lds
    s_branch L_gcom
L_g123:
    s_mov_b32 s44, s10
    s_mov_b32 s45, s11
    s_mov_b32 s46, 524288
    s_mov_b32 s47, 0x20000
    s_cmp_lg_u32 s54, 1
    s_cbranch_scc1 L_gcom
    s_mov_b64 exec, 0xffff
    s_lshl_b32 s62, s2, 11
    buffer_load_dword v6, v10, s[44:47], s62 offen
    s_mov_b64 exec, -1
L_gcom:
    s_mov_b32 s40, s32
    s_mov_b32 s41, s33
    s_mov_b32 s42, 10485760
    s_mov_b32 s43, 0x20000
    s_mov_b32 s48, s30
    s_mov_b32 s49, s31
    s_mov_b32 s50, 256
    s_mov_b32 s51, 0x20000
    s_lshr_b32 s55, s54, 1
    s_and_b32 s56, s54, 1
    v_lshrrev_b32 v7, 3, v0
    v_lshrrev_b32 v8, 2, v0
    v_and_b32 v8, 4, v8
    v_and_b32 v9, 7, v0
    v_xor_b32 v8, v8, v9
    v_lshlrev_b32 v8, 4, v8
    v_lshl_add_u32 v3, v7, 10, v8
    v_mov_b32 v1, 152832
    v_lshrrev_b32 v5, 5, v0
    v_and_b32 v7, 3, v0
    v_and_b32 v8, 16, v0
    v_lshlrev_b32 v8, 1, v8
    v_lshl_add_u32 v4, v7, 3, v8
    s_cmp_eq_u32 s54, 0
    s_cbranch_scc1 L_g0
    s_lshl_b32 s58, s61, 13
    s_lshl_b32 s59, s5, 7
    s_add_u32 s58, s58, s59
    s_lshl_b32 s57, s61, 10
    s_add_u32 s57, s57, 65536
    s_setprio 0
    s_barrier
    s_cmp_lg_u32 s54, 3
    s_cbranch_scc1 L_wqpre
    s_setprio 3
    s_mov_b32 s63, 0
L_epoch:
    buffer_load_dwordx2 v[14:15], off, s[48:51], 0 sc1
    s_add_u32 s63, s63, 1
    s_cmp_gt_u32 s63, 131072
    s_cbranch_scc1 L_gb2
    s_waitcnt vmcnt(0)
    v_readfirstlane_b32 s53, v15
    s_nop 0
    s_cmp_eq_u32 s53, 0
    s_cbranch_scc1 L_epoch
    ds_write_b64 v1, v[14:15] offset:32
    s_mov_b32 s44, s22
    s_mov_b32 s45, s23
    s_mov_b32 s46, 2752
    s_mov_b32 s47, 0x20000
    buffer_load_dword v6, v10, s[44:47], 0 offen
    s_mov_b32 s44, s26
    s_mov_b32 s45, s27
    s_mov_b32 s46, 1024
    s_mov_b32 s47, 0x20000
    buffer_load_dword v6, v10, s[44:47], 0 offen
    s_branch L_gb2
L_wqpre:
L_wqloop:
    s_mov_b32 m0, s57
    s_add_u32 s57, s57, 2048
    buffer_load_dwordx4 v3, s[44:47], s58 offen lds
    s_add_u32 s58, s58, 16384
    s_waitcnt vmcnt(10)
    s_cmp_lt_u32 s57, 131072
    s_cbranch_scc1 L_wqloop
    s_setprio 3
    s_waitcnt vmcnt(16)
    v_mov_b32 v7, 1
    s_mov_b64 exec, 1
    ds_add_u32 v1, v7 offset:16
    s_mov_b64 exec, -1
    s_branch L_gb2
L_g0:
    s_cmp_lg_u32 s2, 0
    s_cbranch_scc1 L_noep
    v_mov_b32 v10, s34
    v_mov_b32 v11, s35
    v_or_b32 v11, 0x80000000, v11
    v_mov_b64 v[12:13], 0
    s_mov_b64 exec, 1
    buffer_atomic_cmpswap_x2 v[10:13], off, s[48:51], 0 sc1
    s_mov_b64 exec, -1
    s_nop 0
L_noep:
    s_barrier
    v_and_b32 v7, 15, v0
    v_lshrrev_b32 v8, 4, v0
    v_lshlrev_b32 v9, 3, v7
    v_lshl_add_u32 v9, v8, 8, v9
    v_add_u32 v9, 131072, v9
    s_lshl_b32 s57, s6, 14
    v_xor_b32 v10, v7, v8
    v_lshlrev_b32 v10, 4, v10
    v_lshl_add_u32 v10, v7, 10, v10
    v_add_u32 v10, s57, v10
    v_xor_b32 v11, 64, v10
    v_xor_b32 v12, 0x80, v10
    v_xor_b32 v13, 0xc0, v10
    s_lshl_b32 s57, s6, 6
    s_add_u32 s57, s57, 149504
    v_lshl_add_u32 v20, v7, 2, s57
    v_lshl_add_u32 v21, v8, 4, s57
    s_cmp_eq_u32 s7, 0
    s_cselect_b32 s60, 0, 65536
    s_cselect_b32 s58, 9, 3
    s_cselect_b32 s59, 3, 9
    v_and_b32 v16, 1, v8
    v_lshlrev_b32 v16, s58, v16
    v_lshrrev_b32 v17, 1, v8
    v_lshl_add_u32 v16, v17, s59, v16
    v_lshl_add_u32 v16, v7, 4, v16
    s_xor_b32 s57, s6, s7
    s_and_b32 s57, s57, 1
    s_lshl_b32 s57, s57, 8
    s_add_u32 s60, s60, s57
    s_lshl_b32 s57, s4, 1
    s_lshr_b32 s58, s6, 1
    s_add_u32 s57, s57, s58
    s_lshl_b32 s57, s57, 10
    s_add_u32 s60, s60, s57
    s_lshl_b32 s57, s4, 3
    s_add_u32 s57, s57, s5
    s_lshl_b32 s57, s57, 5
    s_add_u32 s57, s57, 131072
    s_waitcnt vmcnt(0)
    ds_read_b64_tr_b16 v[32:33], v9 offset:0
    ds_read_b64_tr_b16 v[34:35], v9 offset:128
    ds_read_b64_tr_b16 v[36:37], v9 offset:1024
    ds_read_b64_tr_b16 v[38:39], v9 offset:1152
    ds_read_b64_tr_b16 v[40:41], v9 offset:2048
    ds_read_b64_tr_b16 v[42:43], v9 offset:2176
    ds_read_b64_tr_b16 v[44:45], v9 offset:3072
    ds_read_b64_tr_b16 v[46:47], v9 offset:3200
    ds_read_b64_tr_b16 v[48:49], v9 offset:4096
    ds_read_b64_tr_b16 v[50:51], v9 offset:4224
    ds_read_b64_tr_b16 v[52:53], v9 offset:5120
    ds_read_b64_tr_b16 v[54:55], v9 offset:5248
    ds_read_b64_tr_b16 v[56:57], v9 offset:6144
    ds_read_b64_tr_b16 v[58:59], v9 offset:6272
    ds_read_b64_tr_b16 v[60:61], v9 offset:7168
    ds_read_b64_tr_b16 v[62:63], v9 offset:7296
    ds_read_b64_tr_b16 v[64:65], v9 offset:8192
    ds_read_b64_tr_b16 v[66:67], v9 offset:8320
    ds_read_b64_tr_b16 v[68:69], v9 offset:9216
    ds_read_b64_tr_b16 v[70:71], v9 offset:9344
    ds_read_b64_tr_b16 v[72:73], v9 offset:10240
    ds_read_b64_tr_b16 v[74:75], v9 offset:10368
    ds_read_b64_tr_b16 v[76:77], v9 offset:11264
    ds_read_b64_tr_b16 v[78:79], v9 offset:11392
    ds_read_b64_tr_b16 v[80:81], v9 offset:12288
    ds_read_b64_tr_b16 v[82:83], v9 offset:12416
    ds_read_b64_tr_b16 v[84:85], v9 offset:13312
    ds_read_b64_tr_b16 v[86:87], v9 offset:13440
    ds_read_b64_tr_b16 v[88:89], v9 offset:14336
    ds_read_b64_tr_b16 v[90:91], v9 offset:14464
    ds_read_b64_tr_b16 v[92:93], v9 offset:15360
    ds_read_b64_tr_b16 v[94:95], v9 offset:15488
    s_mov_b32 s63, 0
spin_13:
    ds_read_b32 v14, v1 offset:28
    s_add_u32 s63, s63, 1
    s_waitcnt lgkmcnt(0)
    v_readfirstlane_b32 s62, v14
    s_cmp_gt_u32 s63, 131072
    s_cbranch_scc1 spun_14
    s_cmp_lt_u32 s62, 8
    s_cbranch_scc1 spin_13
spun_14:
    ds_read_b128 v[96:99], v10 offset:0
    ds_read_b128 v[100:103], v11 offset:0
    ds_read_b128 v[104:107], v12 offset:0
    ds_read_b128 v[108:111], v13 offset:0
    ds_read_b128 v[112:115], v10 offset:256
    ds_read_b128 v[116:119], v11 offset:256
    ds_read_b128 v[120:123], v12 offset:256
    ds_read_b128 v[124:127], v13 offset:256
    ds_read_b128 v[128:131], v10 offset:512
    ds_read_b128 v[132:135], v11 offset:512
    ds_read_b128 v[136:139], v12 offset:512
    ds_read_b128 v[140:143], v13 offset:512
    ds_read_b128 v[144:147], v10 offset:768
    ds_read_b128 v[148:151], v11 offset:768
    ds_read_b128 v[152:155], v12 offset:768
    ds_read_b128 v[156:159], v13 offset:768
    s_cmp_eq_u32 s7, 0
    s_cbranch_scc0 L_vchain
    s_waitcnt lgkmcnt(12)
    v_mfma_f32_16x16x32_bf16 v[160:163], v[32:35], v[96:99], 0
    v_mfma_f32_16x16x32_bf16 v[160:163], v[36:39], v[100:103], v[160:163]
    v_mfma_f32_16x16x32_bf16 v[160:163], v[40:43], v[104:107], v[160:163]
    v_mfma_f32_16x16x32_bf16 v[160:163], v[44:47], v[108:111], v[160:163]
    s_waitcnt lgkmcnt(8)
    v_mfma_f32_16x16x32_bf16 v[160:163], v[48:51], v[112:115], v[160:163]
    v_mfma_f32_16x16x32_bf16 v[160:163], v[52:55], v[116:119], v[160:163]
    v_mfma_f32_16x16x32_bf16 v[160:163], v[56:59], v[120:123], v[160:163]
    v_mfma_f32_16x16x32_bf16 v[160:163], v[60:63], v[124:127], v[160:163]
    s_waitcnt lgkmcnt(4)
    v_mfma_f32_16x16x32_bf16 v[160:163], v[64:67], v[128:131], v[160:163]
    v_mfma_f32_16x16x32_bf16 v[160:163], v[68:71], v[132:135], v[160:163]
    v_mfma_f32_16x16x32_bf16 v[160:163], v[72:75], v[136:139], v[160:163]
    v_mfma_f32_16x16x32_bf16 v[160:163], v[76:79], v[140:143], v[160:163]
    s_waitcnt lgkmcnt(0)
    ds_read_b32 v24, v20
    v_mfma_f32_16x16x32_bf16 v[160:163], v[80:83], v[144:147], v[160:163]
    v_mfma_f32_16x16x32_bf16 v[160:163], v[84:87], v[148:151], v[160:163]
    v_mfma_f32_16x16x32_bf16 v[160:163], v[88:91], v[152:155], v[160:163]
    v_mfma_f32_16x16x32_bf16 v[160:163], v[92:95], v[156:159], v[160:163]
    s_waitcnt lgkmcnt(0)
    v_mov_b32 v25, v24
    v_mov_b64 v[26:27], v[24:25]
    s_branch L_kvst
L_vchain:
    s_waitcnt lgkmcnt(12)
    v_mfma_f32_16x16x32_bf16 v[160:163], v[96:99], v[32:35], 0
    v_mfma_f32_16x16x32_bf16 v[160:163], v[100:103], v[36:39], v[160:163]
    v_mfma_f32_16x16x32_bf16 v[160:163], v[104:107], v[40:43], v[160:163]
    v_mfma_f32_16x16x32_bf16 v[160:163], v[108:111], v[44:47], v[160:163]
    s_waitcnt lgkmcnt(8)
    v_mfma_f32_16x16x32_bf16 v[160:163], v[112:115], v[48:51], v[160:163]
    v_mfma_f32_16x16x32_bf16 v[160:163], v[116:119], v[52:55], v[160:163]
    v_mfma_f32_16x16x32_bf16 v[160:163], v[120:123], v[56:59], v[160:163]
    v_mfma_f32_16x16x32_bf16 v[160:163], v[124:127], v[60:63], v[160:163]
    s_waitcnt lgkmcnt(4)
    v_mfma_f32_16x16x32_bf16 v[160:163], v[128:131], v[64:67], v[160:163]
    v_mfma_f32_16x16x32_bf16 v[160:163], v[132:135], v[68:71], v[160:163]
    v_mfma_f32_16x16x32_bf16 v[160:163], v[136:139], v[72:75], v[160:163]
    v_mfma_f32_16x16x32_bf16 v[160:163], v[140:143], v[76:79], v[160:163]
    s_waitcnt lgkmcnt(0)
    ds_read_b128 v[24:27], v21
    v_mfma_f32_16x16x32_bf16 v[160:163], v[144:147], v[80:83], v[160:163]
    v_mfma_f32_16x16x32_bf16 v[160:163], v[148:151], v[84:87], v[160:163]
    v_mfma_f32_16x16x32_bf16 v[160:163], v[152:155], v[88:91], v[160:163]
    v_mfma_f32_16x16x32_bf16 v[160:163], v[156:159], v[92:95], v[160:163]
    s_waitcnt lgkmcnt(0)
    s_nop 2
L_kvst:
    s_nop 3
    v_pk_mul_f32 v[160:161], v[160:161], v[24:25]
    v_pk_mul_f32 v[162:163], v[162:163], v[26:27]
    v_cvt_pk_bf16_f32 v18, v160, v161
    v_cvt_pk_bf16_f32 v19, v162, v163
    buffer_store_dwordx2 v[18:19], v16, s[40:43], s60 offen sc1
    s_mov_b32 s63, 0
spin_15:
    ds_read_b32 v14, v1 offset:36
    s_add_u32 s63, s63, 1
    s_waitcnt lgkmcnt(0)
    v_readfirstlane_b32 s62, v14
    s_cmp_gt_u32 s63, 131072
    s_cbranch_scc1 spun_16
    s_cmp_lt_u32 s62, 1
    s_cbranch_scc1 spin_15
spun_16:
    ds_read_b64 v[20:21], v1 offset:32
    s_getreg_b32 s60, hwreg(HW_REG_XCC_ID)
    v_mov_b32 v22, s60
    v_mov_b32 v23, 0
    s_mov_b64 exec, 1
    s_waitcnt vmcnt(0) lgkmcnt(0)
    buffer_store_dwordx4 v[20:23], off, s[40:43], s57 sc1
    s_mov_b64 exec, -1
    v_mov_b32 v14, 1
    s_mov_b64 exec, 1
    ds_add_u32 v1, v14 offset:56
    s_mov_b64 exec, -1
L_gb2:
    v_bfe_u32 v9, v0, 2, 2
    v_lshrrev_b32 v8, 1, v9
    v_xor_b32 v8, s56, v8
    v_lshl_add_u32 v8, v8, 6, v4
    v_lshl_add_u32 v8, v9, 7, v8
    v_lshl_add_u32 v8, v5, 10, v8
    v_add_u32 v8, 65536, v8
    v_mov_b32 v4, v8
    v_and_b32 v7, 31, v0
    v_and_b32 v9, 15, v0
    v_xor_b32 v9, v9, v5
    v_lshlrev_b32 v9, 4, v9
    v_lshl_add_u32 v7, v7, 10, v9
    s_lshl_b32 s59, s55, 15
    v_add_u32 v7, s59, v7
    s_mov_b32 s44, s20
    s_mov_b32 s45, s21
    s_mov_b32 s46, 1409024
    s_mov_b32 s47, 0x20000
    s_lshl_b32 s0, s5, 2
    s_add_u32 s0, s0, s54
    s_sub_u32 s1, 1, s55
    s_lshl_b32 s1, s1, 3
    s_add_u32 s1, s1, s5
    s_add_u32 s1, s1, 32
    s_cmp_lt_u32 s1, 43
    s_cselect_b32 s61, 12, 8
    s_mul_i32 s35, s54, 12288
    s_add_u32 s35, s35, 65536
    s_lshl_b32 s58, s0, 6
    s_mov_b32 s63, 0
spin_17:
    ds_read_b32 v9, v1 offset:16
    s_add_u32 s63, s63, 1
    s_waitcnt lgkmcnt(0)
    v_readfirstlane_b32 s62, v9
    s_cmp_gt_u32 s63, 131072
    s_cbranch_scc1 spun_18
    s_cmp_ge_u32 s62, 2
    s_cbranch_scc1 spun_18
    s_sleep 1
    s_branch spin_17
spun_18:
    s_cmp_lg_u32 s54, 3
    s_cbranch_scc1 L_t12
    v_lshlrev_b32 v10, 7, v0
    s_mov_b32 exec_hi, 0x7ff
    s_mul_i32 s62, s2, 5504
    buffer_load_dword v6, v10, s[44:47], s62 offen
    s_mov_b64 exec, -1
L_t12:
    ds_read_b64_tr_b16 v[24:25], v4 offset:0
    ds_read_b64_tr_b16 v[26:27], v4 offset:512
    ds_read_b64_tr_b16 v[28:29], v4 offset:16384
    ds_read_b64_tr_b16 v[30:31], v4 offset:16896
    ds_read_b64_tr_b16 v[32:33], v4 offset:2048
    ds_read_b64_tr_b16 v[34:35], v4 offset:2560
    ds_read_b64_tr_b16 v[36:37], v4 offset:18432
    ds_read_b64_tr_b16 v[38:39], v4 offset:18944
    ds_read_b64_tr_b16 v[40:41], v4 offset:4096
    ds_read_b64_tr_b16 v[42:43], v4 offset:4608
    ds_read_b64_tr_b16 v[44:45], v4 offset:20480
    ds_read_b64_tr_b16 v[46:47], v4 offset:20992
    ds_read_b64_tr_b16 v[48:49], v4 offset:6144
    ds_read_b64_tr_b16 v[50:51], v4 offset:6656
    ds_read_b64_tr_b16 v[52:53], v4 offset:22528
    ds_read_b64_tr_b16 v[54:55], v4 offset:23040
    ds_read_b64_tr_b16 v[56:57], v4 offset:8192
    ds_read_b64_tr_b16 v[58:59], v4 offset:8704
    ds_read_b64_tr_b16 v[60:61], v4 offset:24576
    ds_read_b64_tr_b16 v[62:63], v4 offset:25088
    ds_read_b64_tr_b16 v[64:65], v4 offset:10240
    ds_read_b64_tr_b16 v[66:67], v4 offset:10752
    ds_read_b64_tr_b16 v[68:69], v4 offset:26624
    ds_read_b64_tr_b16 v[70:71], v4 offset:27136
    ds_read_b64_tr_b16 v[72:73], v4 offset:12288
    ds_read_b64_tr_b16 v[74:75], v4 offset:12800
    ds_read_b64_tr_b16 v[76:77], v4 offset:28672
    ds_read_b64_tr_b16 v[78:79], v4 offset:29184
    ds_read_b64_tr_b16 v[80:81], v4 offset:14336
    ds_read_b64_tr_b16 v[82:83], v4 offset:14848
    ds_read_b64_tr_b16 v[84:85], v4 offset:30720
    ds_read_b64_tr_b16 v[86:87], v4 offset:31232
    s_sub_u32 s60, s54, 1
    s_cmp_ge_u32 s60, 2
    s_cbranch_scc1 L_wq2
    s_waitcnt vmcnt(0)
    v_mov_b32 v9, 1
    s_mov_b64 exec, 1
    ds_add_u32 v1, v9 offset:52
    s_mov_b64 exec, -1
L_wq2:
    s_mov_b32 s63, 0
spin_19:
    ds_read_b32 v9, v1 offset:52
    s_add_u32 s63, s63, 1
    s_waitcnt lgkmcnt(0)
    v_readfirstlane_b32 s62, v9
    s_cmp_gt_u32 s63, 131072
    s_cbranch_scc1 spun_20
    s_cmp_ge_u32 s62, 2
    s_cbranch_scc1 spun_20
    s_sleep 1
    s_branch spin_19
spun_20:
    ds_read_b64_tr_b16 v[88:89], v4 offset:32768
    ds_read_b64_tr_b16 v[90:91], v4 offset:33280
    ds_read_b64_tr_b16 v[92:93], v4 offset:49152
    ds_read_b64_tr_b16 v[94:95], v4 offset:49664
    ds_read_b64_tr_b16 v[96:97], v4 offset:34816
    ds_read_b64_tr_b16 v[98:99], v4 offset:35328
    ds_read_b64_tr_b16 v[100:101], v4 offset:51200
    ds_read_b64_tr_b16 v[102:103], v4 offset:51712
    ds_read_b64_tr_b16 v[104:105], v4 offset:36864
    ds_read_b64_tr_b16 v[106:107], v4 offset:37376
    ds_read_b64_tr_b16 v[108:109], v4 offset:53248
    ds_read_b64_tr_b16 v[110:111], v4 offset:53760
    ds_read_b64_tr_b16 v[112:113], v4 offset:38912
    ds_read_b64_tr_b16 v[114:115], v4 offset:39424
    ds_read_b64_tr_b16 v[116:117], v4 offset:55296
    ds_read_b64_tr_b16 v[118:119], v4 offset:55808
    ds_read_b64_tr_b16 v[120:121], v4 offset:40960
    ds_read_b64_tr_b16 v[122:123], v4 offset:41472
    ds_read_b64_tr_b16 v[124:125], v4 offset:57344
    ds_read_b64_tr_b16 v[126:127], v4 offset:57856
    ds_read_b64_tr_b16 v[128:129], v4 offset:43008
    ds_read_b64_tr_b16 v[130:131], v4 offset:43520
    ds_read_b64_tr_b16 v[132:133], v4 offset:59392
    ds_read_b64_tr_b16 v[134:135], v4 offset:59904
    ds_read_b64_tr_b16 v[136:137], v4 offset:45056
    ds_read_b64_tr_b16 v[138:139], v4 offset:45568
    ds_read_b64_tr_b16 v[140:141], v4 offset:61440
    ds_read_b64_tr_b16 v[142:143], v4 offset:61952
    ds_read_b64_tr_b16 v[144:145], v4 offset:47104
    ds_read_b64_tr_b16 v[146:147], v4 offset:47616
    ds_read_b64_tr_b16 v[148:149], v4 offset:63488
    ds_read_b64_tr_b16 v[150:151], v4 offset:64000
    s_mov_b32 s63, 0
spin_21:
    ds_read_b32 v9, v1 offset:60
    s_add_u32 s63, s63, 1
    s_waitcnt lgkmcnt(0)
    v_readfirstlane_b32 s62, v9
    s_cmp_gt_u32 s63, 131072
    s_cbranch_scc1 spun_22
    s_cmp_ge_u32 s62, 8
    s_cbranch_scc1 spun_22
    s_sleep 1
    s_branch spin_21
spun_22:
    ds_read_b128 v[152:155], v7 offset:0
    ds_read_b128 v[156:159], v7 offset:256
    ds_read_b128 v[160:163], v7 offset:512
    ds_read_b128 v[164:167], v7 offset:768
    s_waitcnt lgkmcnt(3)
    v_mfma_f32_32x32x16_bf16 v[8:23], v[24:27], v[152:155], 0
    v_xor_b32 v7, 32, v7
    ds_read_b128 v[152:155], v7 offset:0
    ds_read_b128 v[24:27], v7 offset:256
    s_waitcnt lgkmcnt(4)
    v_mfma_f32_32x32x16_bf16 v[8:23], v[28:31], v[156:159], v[8:23]
    ds_read_b128 v[156:159], v7 offset:512
    ds_read_b128 v[28:31], v7 offset:768
    s_waitcnt lgkmcnt(5)
    v_mfma_f32_32x32x16_bf16 v[8:23], v[88:91], v[160:163], v[8:23]
    v_xor_b32 v7, 96, v7
    ds_read_b128 v[160:163], v7 offset:0
    ds_read_b128 v[88:91], v7 offset:256
    s_waitcnt lgkmcnt(6)
    v_mfma_f32_32x32x16_bf16 v[8:23], v[92:95], v[164:167], v[8:23]
    ds_read_b128 v[164:167], v7 offset:512
    ds_read_b128 v[92:95], v7 offset:768
    s_waitcnt lgkmcnt(7)
    v_mfma_f32_32x32x16_bf16 v[8:23], v[32:35], v[152:155], v[8:23]
    v_xor_b32 v7, 32, v7
    ds_read_b128 v[152:155], v7 offset:0
    ds_read_b128 v[32:35], v7 offset:256
    s_waitcnt lgkmcnt(8)
    v_mfma_f32_32x32x16_bf16 v[8:23], v[36:39], v[24:27], v[8:23]
    ds_read_b128 v[24:27], v7 offset:512
    s_waitcnt lgkmcnt(8)
    v_mfma_f32_32x32x16_bf16 v[8:23], v[96:99], v[156:159], v[8:23]
    ds_read_b128 v[156:159], v7 offset:768
    s_waitcnt lgkmcnt(8)
    v_mfma_f32_32x32x16_bf16 v[8:23], v[100:103], v[28:31], v[8:23]
    v_xor_b32 v7, 224, v7
    ds_read_b128 v[28:31], v7 offset:0
    s_waitcnt lgkmcnt(8)
    v_mfma_f32_32x32x16_bf16 v[8:23], v[40:43], v[160:163], v[8:23]
    ds_read_b128 v[160:163], v7 offset:256
    s_waitcnt lgkmcnt(8)
    v_mfma_f32_32x32x16_bf16 v[8:23], v[44:47], v[88:91], v[8:23]
    ds_read_b128 v[88:91], v7 offset:512
    s_waitcnt lgkmcnt(8)
    v_mfma_f32_32x32x16_bf16 v[8:23], v[104:107], v[164:167], v[8:23]
    ds_read_b128 v[164:167], v7 offset:768
    s_waitcnt lgkmcnt(8)
    v_mfma_f32_32x32x16_bf16 v[8:23], v[108:111], v[92:95], v[8:23]
    v_xor_b32 v7, 32, v7
    ds_read_b128 v[92:95], v7 offset:0
    s_waitcnt lgkmcnt(8)
    v_mfma_f32_32x32x16_bf16 v[8:23], v[48:51], v[152:155], v[8:23]
    ds_read_b128 v[152:155], v7 offset:256
    s_waitcnt lgkmcnt(8)
    v_mfma_f32_32x32x16_bf16 v[8:23], v[52:55], v[32:35], v[8:23]
    ds_read_b128 v[32:35], v7 offset:512
    s_waitcnt lgkmcnt(8)
    v_mfma_f32_32x32x16_bf16 v[8:23], v[112:115], v[24:27], v[8:23]
    ds_read_b128 v[24:27], v7 offset:768
    s_waitcnt lgkmcnt(8)
    v_mfma_f32_32x32x16_bf16 v[8:23], v[116:119], v[156:159], v[8:23]
    v_xor_b32 v7, 96, v7
    ds_read_b128 v[156:159], v7 offset:0
    s_waitcnt lgkmcnt(8)
    v_mfma_f32_32x32x16_bf16 v[8:23], v[56:59], v[28:31], v[8:23]
    ds_read_b128 v[28:31], v7 offset:256
    s_waitcnt lgkmcnt(8)
    v_mfma_f32_32x32x16_bf16 v[8:23], v[60:63], v[160:163], v[8:23]
    ds_read_b128 v[160:163], v7 offset:512
    s_waitcnt lgkmcnt(8)
    v_mfma_f32_32x32x16_bf16 v[8:23], v[120:123], v[88:91], v[8:23]
    ds_read_b128 v[88:91], v7 offset:768
    s_waitcnt lgkmcnt(8)
    v_mfma_f32_32x32x16_bf16 v[8:23], v[124:127], v[164:167], v[8:23]
    v_xor_b32 v7, 32, v7
    ds_read_b128 v[164:167], v7 offset:0
    s_waitcnt lgkmcnt(8)
    v_mfma_f32_32x32x16_bf16 v[8:23], v[64:67], v[92:95], v[8:23]
    ds_read_b128 v[92:95], v7 offset:256
    s_waitcnt lgkmcnt(8)
    v_mfma_f32_32x32x16_bf16 v[8:23], v[68:71], v[152:155], v[8:23]
    ds_read_b128 v[152:155], v7 offset:512
    s_waitcnt lgkmcnt(8)
    v_mfma_f32_32x32x16_bf16 v[8:23], v[128:131], v[32:35], v[8:23]
    ds_read_b128 v[32:35], v7 offset:768
    s_waitcnt lgkmcnt(8)
    v_mfma_f32_32x32x16_bf16 v[8:23], v[132:135], v[24:27], v[8:23]
    s_waitcnt lgkmcnt(7)
    v_mfma_f32_32x32x16_bf16 v[8:23], v[72:75], v[156:159], v[8:23]
    s_waitcnt lgkmcnt(6)
    v_mfma_f32_32x32x16_bf16 v[8:23], v[76:79], v[28:31], v[8:23]
    s_waitcnt lgkmcnt(5)
    v_mfma_f32_32x32x16_bf16 v[8:23], v[136:139], v[160:163], v[8:23]
    s_waitcnt lgkmcnt(4)
    v_mfma_f32_32x32x16_bf16 v[8:23], v[140:143], v[88:91], v[8:23]
    s_waitcnt lgkmcnt(3)
    v_mfma_f32_32x32x16_bf16 v[8:23], v[80:83], v[164:167], v[8:23]
    s_waitcnt lgkmcnt(2)
    v_mfma_f32_32x32x16_bf16 v[8:23], v[84:87], v[92:95], v[8:23]
    s_waitcnt lgkmcnt(1)
    v_mfma_f32_32x32x16_bf16 v[8:23], v[144:147], v[152:155], v[8:23]
    s_waitcnt lgkmcnt(0)
    v_mfma_f32_32x32x16_bf16 v[8:23], v[148:151], v[32:35], v[8:23]
    v_and_b32 v7, 31, v0
    v_lshlrev_b32 v152, 2, v7
    v_add_u32 v152, 149504, v152
    v_add_u32 v153, 147456, v2
    s_mov_b32 s63, 0
L_rs:
    ds_read_b32 v164, v1 offset:24
    ds_read_b32 v166, v152
    ds_read_b32 v167, v152 offset:128
    ds_read_b64 v[154:155], v1 offset:32
    ds_read_b128 v[156:159], v153
    ds_read_b128 v[100:103], v153 offset:1024
    s_add_u32 s63, s63, 1
    s_cmp_gt_u32 s63, 131072
    s_cbranch_scc1 L_rsd
    s_waitcnt lgkmcnt(5)
    v_readfirstlane_b32 s62, v164
    s_nop 0
    s_cmp_lt_u32 s62, 9
    s_cbranch_scc1 L_rs
L_rsd:
    s_lshl_b32 s57, s56, 2
    s_add_u32 s57, s57, s55
    s_mul_i32 s57, s57, 1536
    s_add_u32 s57, s57, 151552
    v_add_u32 v162, s57, v2
    v_lshl_add_u32 v163, v0, 2, s57
    s_cmp_eq_u32 s55, 0
    s_cselect_b64 vcc, -1, 0
    s_waitcnt lgkmcnt(0)
    v_readfirstlane_b32 s52, v154
    v_cndmask_b32 v160, v167, v166, vcc
    v_readfirstlane_b32 s53, v155
    v_mul_f32 v160, 0x3eb8aa3b, v160
    v_pk_mul_f32 v[8:9], v[8:9], v[160:161] op_sel_hi:[1,0]
    v_pk_mul_f32 v[10:11], v[10:11], v[160:161] op_sel_hi:[1,0]
    v_pk_mul_f32 v[12:13], v[12:13], v[160:161] op_sel_hi:[1,0]
    v_pk_mul_f32 v[14:15], v[14:15], v[160:161] op_sel_hi:[1,0]
    v_cvt_pk_bf16_f32 v8, v8, v9
    v_cvt_pk_bf16_f32 v9, v10, v11
    v_cvt_pk_bf16_f32 v10, v12, v13
    v_cvt_pk_bf16_f32 v11, v14, v15
    ds_write_b128 v162, v[8:11] offset:0
    s_nop 0
    v_mfma_f32_32x32x16_bf16 v[24:39], v[156:159], v[8:11], 0
    v_mfma_f32_32x32x16_bf16 v[68:83], v[100:103], v[8:11], 0
    v_pk_mul_f32 v[16:17], v[16:17], v[160:161] op_sel_hi:[1,0]
    v_pk_mul_f32 v[18:19], v[18:19], v[160:161] op_sel_hi:[1,0]
    v_pk_mul_f32 v[20:21], v[20:21], v[160:161] op_sel_hi:[1,0]
    v_pk_mul_f32 v[22:23], v[22:23], v[160:161] op_sel_hi:[1,0]
    v_cvt_pk_bf16_f32 v12, v16, v17
    v_cvt_pk_bf16_f32 v13, v18, v19
    v_cvt_pk_bf16_f32 v14, v20, v21
    v_cvt_pk_bf16_f32 v15, v22, v23
    ds_write_b128 v162, v[12:15] offset:3072
    s_nop 0
    v_mfma_f32_32x32x16_bf16 v[40:55], v[156:159], v[12:15], 0
    v_mfma_f32_32x32x16_bf16 v[84:99], v[100:103], v[12:15], 0
    s_nop 1
    v_max3_f32 v56, v24, v25, v26
    v_max3_f32 v56, v56, v27, v28
    v_max3_f32 v56, v56, v29, v30
    v_max3_f32 v56, v56, v31, v32
    v_max3_f32 v56, v56, v33, v34
    v_max3_f32 v56, v56, v35, v36
    v_max3_f32 v56, v56, v37, v38
    v_max_f32 v56, v56, v39
    v_max3_f32 v56, v56, v68, v69
    v_max3_f32 v56, v56, v70, v71
    v_max3_f32 v56, v56, v72, v73
    v_max3_f32 v56, v56, v74, v75
    v_max3_f32 v56, v56, v76, v77
    v_max3_f32 v56, v56, v78, v79
    v_max3_f32 v56, v56, v80, v81
    v_max3_f32 v56, v56, v82, v83
    v_mov_b32 v57, v56
    s_nop 1
    v_permlane32_swap_b32 v56, v57
    v_max3_f32 v58, v40, v41, v42
    v_max3_f32 v58, v58, v43, v44
    v_max3_f32 v58, v58, v45, v46
    v_max3_f32 v58, v58, v47, v48
    v_max3_f32 v58, v58, v49, v50
    v_max3_f32 v58, v58, v51, v52
    v_max3_f32 v58, v58, v53, v54
    v_max_f32 v58, v58, v55
    v_max3_f32 v58, v58, v84, v85
    v_max3_f32 v58, v58, v86, v87
    v_max3_f32 v58, v58, v88, v89
    v_max3_f32 v58, v58, v90, v91
    v_max3_f32 v58, v58, v92, v93
    v_max3_f32 v58, v58, v94, v95
    v_max3_f32 v58, v58, v96, v97
    v_max3_f32 v58, v58, v98, v99
    v_mov_b32 v59, v58
    v_max_f32 v56, v56, v57
    v_sub_u32 v62, v5, 1
    v_permlane32_swap_b32 v58, v59
    v_sub_f32 v60, -102.0, v56
    v_lshlrev_b32 v62, 16, v62
    v_max_f32 v58, v58, v59
    v_and_b32 v60, v62, v60
    v_sub_f32 v64, -102.0, v58
    ds_write_b32 v163, v60 offset:1024
    v_and_b32 v64, v62, v64
    ds_write_b32 v163, v64 offset:4096
    v_mov_b32 v26, 1
    s_mov_b64 exec, 1
    ds_add_u32 v1, v26 offset:0
    s_mov_b64 exec, -1
    v_lshrrev_b32 v44, 2, v0
    v_and_b32 v45, 3, v0
    v_mul_u32_u24 v44, 2752, v44
    v_lshl_add_u32 v20, v45, 4, v44
    v_add_u32 v21, 351232, v20
    v_add_u32 v22, 702464, v20
    v_add_u32 v23, 1053696, v20
    v_and_b32 v44, 16, v0
    v_lshlrev_b32 v44, 1, v44
    v_lshl_add_u32 v4, v45, 3, v44
    s_waitcnt vmcnt(0)
    v_lshlrev_b32 v40, 1, v7
    v_and_b32 v41, 7, v0
    v_lshlrev_b32 v41, 5, v41
    v_and_b32 v44, 15, v0
    v_xor_b32 v44, v44, v5
    v_lshlrev_b32 v44, 4, v44
    v_lshl_add_u32 v16, v7, 10, v44
    v_bfe_u32 v44, v0, 2, 2
    v_lshl_add_u32 v19, v44, 6, v4
    v_lshl_add_u32 v19, v5, 9, v19
    v_add_u32 v19, s35, v19
    v_rcp_f32 v44, v166
    v_rcp_f32 v45, v167
    v_sub_u32 v48, v5, 1
    s_mov_b32 s60, 0xffff0000
    v_and_b32 v46, s60, v44
    v_and_b32 v47, s60, v45
    v_sub_f32 v44, v44, v46
    v_sub_f32 v45, v45, v47
    v_cvt_pk_bf16_f32 v12, v46, v44
    v_cvt_pk_bf16_f32 v14, v47, v45
    v_and_b32 v12, v48, v12
    v_and_b32 v14, v48, v14
    v_mov_b32 v9, 0
    v_mov_b64 v[10:11], 0
    v_mov_b32 v13, 0
    v_mul_f32 v6, v166, v166
    v_mul_f32 v7, v167, v167
    v_mov_b32 v18, v19
    v_mov_b32 v17, v16
    s_mov_b32 s57, 0
    s_mov_b32 s34, 0
    v_mfma_f32_32x32x8_bf16 v[104:119], v[10:11], v[10:11], 0
    v_mfma_f32_32x32x8_bf16 v[120:135], v[10:11], v[10:11], 0
    s_mul_i32 s10, s56, 176128
    s_lshl_b32 s60, s1, 6
    s_add_u32 s10, s10, s60
    s_mov_b32 s18, 1228937984
    s_cmp_lt_u32 s5, 3
    s_cselect_b32 s60, 4, 0
    s_add_u32 s60, s60, s54
    s_cmp_eq_u32 s60, 1
    s_cselect_b32 s18, 1363745298, s18
    s_cmp_eq_u32 s60, 2
    s_cselect_b32 s18, 872419364, s18
    s_cmp_eq_u32 s60, 3
    s_cselect_b32 s18, 1448186164, s18
    s_cmp_eq_u32 s60, 4
    s_cselect_b32 s18, 369104384, s18
    s_cmp_eq_u32 s60, 5
    s_cselect_b32 s18, 1128273174, s18
    s_cmp_eq_u32 s60, 6
    s_cselect_b32 s18, 1279497512, s18
    s_cmp_eq_u32 s60, 7
    s_cselect_b32 s18, 1447859764, s18
    s_lshr_b32 s60, s18, 24
    s_mov_b32 s36, s24
    s_mov_b32 s37, s25
    s_lshl_b32 s38, s60, 14
    s_mov_b32 s39, 0x20000
    s_and_b32 s19, s18, 0xff
    s_lshl_b32 s19, s19, 14
    s_lshl_b32 s60, s5, 7
    s_add_u32 s19, s19, s60
    s_mov_b32 s48, s22
    s_mov_b32 s49, s23
    s_mov_b32 s50, 2752
    s_mov_b32 s51, 0x20000
    s_mov_b32 s63, 0
spin_23:
    ds_read_b32 v56, v1 offset:0
    s_add_u32 s63, s63, 1
    s_waitcnt lgkmcnt(0)
    v_readfirstlane_b32 s62, v56
    s_cmp_gt_u32 s63, 131072
    s_cbranch_scc1 spun_24
    s_cmp_lt_u32 s62, 4
    s_cbranch_scc1 spin_23
spun_24:
    s_mov_b32 s63, 0
spin_25:
    ds_read_b32 v56, v1 offset:20
    s_add_u32 s63, s63, 1
    s_waitcnt lgkmcnt(0)
    v_readfirstlane_b32 s62, v56
    s_cmp_gt_u32 s63, 131072
    s_cbranch_scc1 spun_26
    s_cmp_ge_u32 s62, 8
    s_cbranch_scc1 spun_26
    s_sleep 2
    s_branch spin_25
spun_26:
    s_add_u32 m0, s35, 0
    s_nop 0
    buffer_load_dwordx4 v20, s[44:47], s58 offen offset:0 lds
    buffer_load_dwordx4 v21, s[44:47], s58 offen offset:1024 lds
    buffer_load_dwordx4 v22, s[44:47], s58 offen offset:2048 lds
    buffer_load_dwordx4 v23, s[44:47], s58 offen offset:3072 lds
    s_add_u32 s58, s58, 44032
    s_add_u32 m0, s35, 4096
    s_nop 0
    buffer_load_dwordx4 v20, s[44:47], s58 offen offset:0 lds
    buffer_load_dwordx4 v21, s[44:47], s58 offen offset:1024 lds
    buffer_load_dwordx4 v22, s[44:47], s58 offen offset:2048 lds
    buffer_load_dwordx4 v23, s[44:47], s58 offen offset:3072 lds
    s_add_u32 s58, s58, 44032
    s_add_u32 m0, s35, 8192
    s_nop 0
    buffer_load_dwordx4 v20, s[44:47], s58 offen offset:0 lds
    buffer_load_dwordx4 v21, s[44:47], s58 offen offset:1024 lds
    buffer_load_dwordx4 v22, s[44:47], s58 offen offset:2048 lds
    buffer_load_dwordx4 v23, s[44:47], s58 offen offset:3072 lds
    s_add_u32 s58, s58, 44032
    s_lshl_b32 s59, s0, 6
    s_lshl_b32 s60, s1, 6
    s_lshl_b32 s62, s4, 8
    s_add_u32 s62, s62, 131072
    buffer_load_ushort v8, v40, s[48:51], s59 offen
    buffer_load_ushort v15, v40, s[48:51], s60 offen
    buffer_load_dword v138, v41, s[40:43], s62 offen offset:8 sc1
    s_waitcnt vmcnt(11)
    ds_read_b64_tr_b16 v[24:25], v18 offset:0
    ds_read_b64_tr_b16 v[26:27], v18 offset:256
    ds_read_b128 v[28:31], v17 offset:0
    ds_read_b128 v[88:91], v17 offset:32768
    ds_read_b64_tr_b16 v[32:33], v18 offset:1024
    ds_read_b64_tr_b16 v[34:35], v18 offset:1280
    ds_read_b128 v[36:39], v17 offset:256
    ds_read_b128 v[92:95], v17 offset:33024
    ds_read_b64_tr_b16 v[40:41], v18 offset:2048
    ds_read_b64_tr_b16 v[42:43], v18 offset:2304
    ds_read_b128 v[44:47], v17 offset:512
    ds_read_b128 v[96:99], v17 offset:33280
    ds_read_b64_tr_b16 v[48:49], v18 offset:3072
    ds_read_b64_tr_b16 v[50:51], v18 offset:3328
    ds_read_b128 v[52:55], v17 offset:768
    ds_read_b128 v[100:103], v17 offset:33536
.p2align 6
L_f1loop:
    s_add_u32 m0, s34, s35
    s_add_u32 s34, s34, 4096
    s_cmp_lt_u32 s34, 12288
    s_cselect_b32 s34, s34, 0
    s_add_u32 s57, s57, 1
    s_lshr_b32 s60, s57, 3
    s_and_b32 s60, s60, s56
    s_lshl_b32 s60, s60, 2
    s_add_u32 s60, s60, s57
    s_and_b32 s60, s60, 7
    s_lshl_b32 s60, s60, 5
    v_add_u32 v18, s34, v19
    v_xor_b32 v17, s60, v16
    s_add_u32 s60, s57, 2
    s_cmp_ge_u32 s60, s61
    s_cbranch_scc1 L_f1t0
L_f1r0:
    s_waitcnt lgkmcnt(12)
    s_setprio 0
    v_mfma_f32_32x32x16_bf16 v[104:119], v[24:27], v[28:31], v[104:119]
    s_setprio 3
    buffer_load_dwordx4 v20, s[44:47], s58 offen offset:0 lds
    ds_read_b128 v[60:63], v17 offset:0
    ds_read_b128 v[152:155], v17 offset:32768
    s_setprio 0
    v_mfma_f32_32x32x16_bf16 v[120:135], v[24:27], v[88:91], v[120:135]
    s_setprio 3
    s_waitcnt vmcnt(8)
    ds_read_b64_tr_b16 v[56:57], v18 offset:0
    ds_read_b64_tr_b16 v[58:59], v18 offset:256
    s_waitcnt lgkmcnt(12)
    s_setprio 0
    v_mfma_f32_32x32x16_bf16 v[104:119], v[32:35], v[36:39], v[104:119]
    s_setprio 3
    buffer_load_dwordx4 v21, s[44:47], s58 offen offset:1024 lds
    ds_read_b128 v[68:71], v17 offset:256
    ds_read_b128 v[156:159], v17 offset:33024
    s_setprio 0
    v_mfma_f32_32x32x16_bf16 v[120:135], v[32:35], v[92:95], v[120:135]
    s_setprio 3
    s_waitcnt vmcnt(8)
    ds_read_b64_tr_b16 v[64:65], v18 offset:1024
    ds_read_b64_tr_b16 v[66:67], v18 offset:1280
    s_waitcnt lgkmcnt(12)
    s_setprio 0
    v_mfma_f32_32x32x16_bf16 v[104:119], v[40:43], v[44:47], v[104:119]
    s_setprio 3
    buffer_load_dwordx4 v22, s[44:47], s58 offen offset:2048 lds
    ds_read_b128 v[76:79], v17 offset:512
    ds_read_b128 v[160:163], v17 offset:33280
    s_setprio 0
    v_mfma_f32_32x32x16_bf16 v[120:135], v[40:43], v[96:99], v[120:135]
    s_setprio 3
    s_waitcnt vmcnt(8)
    ds_read_b64_tr_b16 v[72:73], v18 offset:2048
    ds_read_b64_tr_b16 v[74:75], v18 offset:2304
    s_waitcnt lgkmcnt(12)
    s_setprio 0
    v_mfma_f32_32x32x16_bf16 v[104:119], v[48:51], v[52:55], v[104:119]
    s_setprio 3
    buffer_load_dwordx4 v23, s[44:47], s58 offen offset:3072 lds
    ds_read_b128 v[84:87], v17 offset:768
    ds_read_b128 v[164:167], v17 offset:33536
    s_setprio 0
    v_mfma_f32_32x32x16_bf16 v[120:135], v[48:51], v[100:103], v[120:135]
    s_setprio 3
    s_waitcnt vmcnt(8)
    ds_read_b64_tr_b16 v[80:81], v18 offset:3072
    ds_read_b64_tr_b16 v[82:83], v18 offset:3328
    s_add_u32 s58, s58, 44032
    s_add_u32 m0, s34, s35
    s_add_u32 s34, s34, 4096
    s_cmp_lt_u32 s34, 12288
    s_cselect_b32 s34, s34, 0
    s_add_u32 s57, s57, 1
    s_lshr_b32 s60, s57, 3
    s_and_b32 s60, s60, s56
    s_lshl_b32 s60, s60, 2
    s_add_u32 s60, s60, s57
    s_and_b32 s60, s60, 7
    s_lshl_b32 s60, s60, 5
    v_add_u32 v18, s34, v19
    v_xor_b32 v17, s60, v16
    s_cmp_eq_u32 s57, 6
    s_cselect_b32 s58, s10, s58
    s_add_u32 s60, s57, 2
    s_cmp_ge_u32 s60, s61
    s_cbranch_scc1 L_f1t1
L_f1r1:
    s_waitcnt lgkmcnt(12)
    s_setprio 0
    v_mfma_f32_32x32x16_bf16 v[104:119], v[56:59], v[60:63], v[104:119]
    s_setprio 3
    buffer_load_dwordx4 v20, s[44:47], s58 offen offset:0 lds
    ds_read_b128 v[28:31], v17 offset:0
    ds_read_b128 v[88:91], v17 offset:32768
    s_setprio 0
    v_mfma_f32_32x32x16_bf16 v[120:135], v[56:59], v[152:155], v[120:135]
    s_setprio 3
    s_waitcnt vmcnt(8)
    ds_read_b64_tr_b16 v[24:25], v18 offset:0
    ds_read_b64_tr_b16 v[26:27], v18 offset:256
    s_waitcnt lgkmcnt(12)
    s_setprio 0
    v_mfma_f32_32x32x16_bf16 v[104:119], v[64:67], v[68:71], v[104:119]
    s_setprio 3
    buffer_load_dwordx4 v21, s[44:47], s58 offen offset:1024 lds
    ds_read_b128 v[36:39], v17 offset:256
    ds_read_b128 v[92:95], v17 offset:33024
    s_setprio 0
    v_mfma_f32_32x32x16_bf16 v[120:135], v[64:67], v[156:159], v[120:135]
    s_setprio 3
    s_waitcnt vmcnt(8)
    ds_read_b64_tr_b16 v[32:33], v18 offset:1024
    ds_read_b64_tr_b16 v[34:35], v18 offset:1280
    s_waitcnt lgkmcnt(12)
    s_setprio 0
    v_mfma_f32_32x32x16_bf16 v[104:119], v[72:75], v[76:79], v[104:119]
    s_setprio 3
    buffer_load_dwordx4 v22, s[44:47], s58 offen offset:2048 lds
    ds_read_b128 v[44:47], v17 offset:512
    ds_read_b128 v[96:99], v17 offset:33280
    s_setprio 0
    v_mfma_f32_32x32x16_bf16 v[120:135], v[72:75], v[160:163], v[120:135]
    s_setprio 3
    s_waitcnt vmcnt(8)
    ds_read_b64_tr_b16 v[40:41], v18 offset:2048
    ds_read_b64_tr_b16 v[42:43], v18 offset:2304
    s_waitcnt lgkmcnt(12)
    s_setprio 0
    v_mfma_f32_32x32x16_bf16 v[104:119], v[80:83], v[84:87], v[104:119]
    s_setprio 3
    buffer_load_dwordx4 v23, s[44:47], s58 offen offset:3072 lds
    ds_read_b128 v[52:55], v17 offset:768
    ds_read_b128 v[100:103], v17 offset:33536
    s_setprio 0
    v_mfma_f32_32x32x16_bf16 v[120:135], v[80:83], v[164:167], v[120:135]
    s_setprio 3
    s_waitcnt vmcnt(8)
    ds_read_b64_tr_b16 v[48:49], v18 offset:3072
    ds_read_b64_tr_b16 v[50:51], v18 offset:3328
    s_add_u32 s58, s58, 44032
    s_cmp_lt_u32 s57, 8
    s_cbranch_scc1 L_f1loop
    s_cmp_eq_u32 s57, 10
    s_cbranch_scc1 L_f1pub
    s_getreg_b32 s60, hwreg(HW_REG_XCC_ID)
    v_lshl_or_b32 v8, v8, 16, v8
    v_cmp_ne_u32 vcc, s60, v138
    s_mul_i32 s60, s4, 86
    s_lshl_b32 s59, s0, 1
    s_add_u32 s60, s60, s59
    s_lshl_b32 s60, s60, 11
    s_add_u32 s60, s60, 2359296
    s_mov_b32 s0, s1
    s_cmp_eq_u64 vcc, 0
    s_cselect_b32 s25, 1, 0
    s_cmp_eq_u32 s57, 12
    s_cbranch_scc1 L_half
    s_setprio 0
    v_mfma_f32_32x32x16_bf16 v[104:119], v[8:11], v[12:15], v[104:119]
    s_setprio 3
    s_setprio 0
    v_mfma_f32_32x32x16_bf16 v[120:135], v[8:11], v[14:17], v[120:135]
    s_setprio 3
    v_mov_b32 v8, v15
    s_nop 9
L_epi0:
    v_max_f32 v104, 0, v104
    v_max_f32 v105, 0, v105
    v_max_f32 v106, 0, v106
    v_max_f32 v107, 0, v107
    v_max_f32 v108, 0, v108
    v_max_f32 v109, 0, v109
    v_max_f32 v110, 0, v110
    v_max_f32 v111, 0, v111
    v_max_f32 v112, 0, v112
    v_max_f32 v113, 0, v113
    v_max_f32 v114, 0, v114
    v_max_f32 v115, 0, v115
    v_max_f32 v116, 0, v116
    v_max_f32 v117, 0, v117
    v_max_f32 v118, 0, v118
    v_max_f32 v119, 0, v119
    v_pk_mul_f32 v[104:105], v[104:105], v[104:105]
    v_pk_mul_f32 v[106:107], v[106:107], v[106:107]
    v_pk_mul_f32 v[108:109], v[108:109], v[108:109]
    v_pk_mul_f32 v[110:111], v[110:111], v[110:111]
    v_pk_mul_f32 v[112:113], v[112:113], v[112:113]
    v_pk_mul_f32 v[114:115], v[114:115], v[114:115]
    v_pk_mul_f32 v[116:117], v[116:117], v[116:117]
    v_pk_mul_f32 v[118:119], v[118:119], v[118:119]
    v_pk_mul_f32 v[104:105], v[104:105], v[6:7] op_sel_hi:[1,0]
    v_pk_mul_f32 v[106:107], v[106:107], v[6:7] op_sel_hi:[1,0]
    v_pk_mul_f32 v[108:109], v[108:109], v[6:7] op_sel_hi:[1,0]
    v_pk_mul_f32 v[110:111], v[110:111], v[6:7] op_sel_hi:[1,0]
    v_pk_mul_f32 v[112:113], v[112:113], v[6:7] op_sel_hi:[1,0]
    v_pk_mul_f32 v[114:115], v[114:115], v[6:7] op_sel_hi:[1,0]
    v_pk_mul_f32 v[116:117], v[116:117], v[6:7] op_sel_hi:[1,0]
    v_pk_mul_f32 v[118:119], v[118:119], v[6:7] op_sel_hi:[1,0]
    v_cvt_pk_bf16_f32 v104, v104, v105
    v_cvt_pk_bf16_f32 v105, v106, v107
    v_cvt_pk_bf16_f32 v106, v108, v109
    v_cvt_pk_bf16_f32 v107, v110, v111
    v_cvt_pk_bf16_f32 v108, v112, v113
    v_cvt_pk_bf16_f32 v109, v114, v115
    v_cvt_pk_bf16_f32 v110, v116, v117
    v_cvt_pk_bf16_f32 v111, v118, v119
    buffer_store_dwordx4 v[104:107], v2, s[40:43], s60 offen offset:0 sc1
    buffer_store_dwordx4 v[108:111], v2, s[40:43], s60 offen offset:2048 sc1
    s_cmp_eq_u32 s57, 12
    s_cbranch_scc1 L_epid
L_epi1:
    v_max_f32 v120, 0, v120
    v_max_f32 v121, 0, v121
    v_max_f32 v122, 0, v122
    v_max_f32 v123, 0, v123
    v_max_f32 v124, 0, v124
    v_max_f32 v125, 0, v125
    v_max_f32 v126, 0, v126
    v_max_f32 v127, 0, v127
    v_max_f32 v128, 0, v128
    v_max_f32 v129, 0, v129
    v_max_f32 v130, 0, v130
    v_max_f32 v131, 0, v131
    v_max_f32 v132, 0, v132
    v_max_f32 v133, 0, v133
    v_max_f32 v134, 0, v134
    v_max_f32 v135, 0, v135
    v_pk_mul_f32 v[120:121], v[120:121], v[120:121]
    v_pk_mul_f32 v[122:123], v[122:123], v[122:123]
    v_pk_mul_f32 v[124:125], v[124:125], v[124:125]
    v_pk_mul_f32 v[126:127], v[126:127], v[126:127]
    v_pk_mul_f32 v[128:129], v[128:129], v[128:129]
    v_pk_mul_f32 v[130:131], v[130:131], v[130:131]
    v_pk_mul_f32 v[132:133], v[132:133], v[132:133]
    v_pk_mul_f32 v[134:135], v[134:135], v[134:135]
    v_pk_mul_f32 v[120:121], v[120:121], v[6:7] op_sel:[0,1] op_sel_hi:[1,1]
    v_pk_mul_f32 v[122:123], v[122:123], v[6:7] op_sel:[0,1] op_sel_hi:[1,1]
    v_pk_mul_f32 v[124:125], v[124:125], v[6:7] op_sel:[0,1] op_sel_hi:[1,1]
    v_pk_mul_f32 v[126:127], v[126:127], v[6:7] op_sel:[0,1] op_sel_hi:[1,1]
    v_pk_mul_f32 v[128:129], v[128:129], v[6:7] op_sel:[0,1] op_sel_hi:[1,1]
    v_pk_mul_f32 v[130:131], v[130:131], v[6:7] op_sel:[0,1] op_sel_hi:[1,1]
    v_pk_mul_f32 v[132:133], v[132:133], v[6:7] op_sel:[0,1] op_sel_hi:[1,1]
    v_pk_mul_f32 v[134:135], v[134:135], v[6:7] op_sel:[0,1] op_sel_hi:[1,1]
    v_cvt_pk_bf16_f32 v120, v120, v121
    v_cvt_pk_bf16_f32 v121, v122, v123
    v_cvt_pk_bf16_f32 v122, v124, v125
    v_cvt_pk_bf16_f32 v123, v126, v127
    v_cvt_pk_bf16_f32 v124, v128, v129
    v_cvt_pk_bf16_f32 v125, v130, v131
    v_cvt_pk_bf16_f32 v126, v132, v133
    v_cvt_pk_bf16_f32 v127, v134, v135
    buffer_store_dwordx4 v[120:123], v2, s[40:43], s60 offen offset:1024 sc1
    buffer_store_dwordx4 v[124:127], v2, s[40:43], s60 offen offset:3072 sc1
L_epid:
    s_nop 0
    s_setprio 0
    v_mfma_f32_32x32x8_bf16 v[104:119], v[10:11], v[10:11], 0
    s_setprio 3
    s_setprio 0
    v_mfma_f32_32x32x8_bf16 v[120:135], v[10:11], v[10:11], 0
    s_setprio 3
    s_cmp_lt_u32 s57, s61
    s_cbranch_scc1 L_f1loop
    v_add_u32 v22, 7168, v3
    s_add_u32 s19, s19, 98304
    s_cmp_eq_u32 s57, 8
    s_cbranch_scc1 L_f1fill
    s_sub_u32 s19, s19, 32768
    s_mov_b32 s63, 0
spin_27:
    ds_read_b32 v27, v26 offset:40
    s_add_u32 s63, s63, 1
    s_waitcnt lgkmcnt(0)
    v_readfirstlane_b32 s62, v27
    s_cmp_gt_u32 s63, 131072
    s_cbranch_scc1 spun_28
    s_cmp_lt_u32 s62, 4
    s_cbranch_scc1 spin_27
spun_28:
    s_add_u32 m0, s35, 8192
    s_nop 0
    buffer_load_dwordx4 v3, s[36:39], s19 offen lds
    buffer_load_dwordx4 v22, s[36:39], s19 offen offset:1024 lds
    s_add_u32 s19, s19, 16384
    s_add_u32 m0, s35, 10240
    s_nop 0
    buffer_load_dwordx4 v3, s[36:39], s19 offen lds
    buffer_load_dwordx4 v22, s[36:39], s19 offen offset:1024 lds
    s_add_u32 s19, s19, 16384
L_f1fill:
    s_waitcnt lgkmcnt(0)
    s_mov_b32 s44, s8
    s_mov_b32 s45, s9
    s_mov_b32 s46, 2097152
    s_mov_b32 s47, 0x20000
    s_mov_b32 s48, s26
    s_mov_b32 s49, s27
    s_mov_b32 s50, 1024
    s_mov_b32 s51, 0x20000
    v_and_b32 v23, 31, v0
    v_lshlrev_b32 v7, 4, v5
    v_lshl_add_u32 v7, v23, 10, v7
    v_lshlrev_b32 v23, 1, v23
    s_lshl_b32 s62, s5, 7
    s_lshl_b32 s60, s56, 6
    s_add_u32 s62, s62, s60
    s_lshl_b32 s60, s4, 16
    s_lshl_b32 s59, s55, 15
    s_add_u32 s60, s60, s59
    s_add_u32 s61, s60, s62
    s_lshl_b32 s60, s55, 10
    buffer_load_dwordx4 v[80:83], v7, s[44:47], s61 offen
    buffer_load_dwordx4 v[84:87], v7, s[44:47], s61 offen offset:32
    buffer_load_ushort v76, v23, s[48:51], s62 offen
    v_add_u32 v10, s60, v2
    v_xor_b32 v11, 0x400, v10
    v_and_b32 v12, 7, v0
    v_lshlrev_b32 v12, 7, v12
    s_lshl_b32 s9, s4, 10
    s_add_u32 s9, s9, 163840
    s_mul_i32 s8, s4, 176128
    s_add_u32 s8, s8, 2359296
    s_and_b32 s31, s18, 0xff
    s_lshl_b32 s31, s31, 11
    s_add_u32 s31, s31, s8
    s_mov_b32 s21, 0
    s_cmp_eq_u32 s57, 8
    s_cbranch_scc1 L_nopre
    s_waitcnt vmcnt(9)
    v_cmp_ne_u64 vcc, s[52:53], v[140:141]
    s_nop 1
    s_cbranch_vccnz L_nopre
    s_mov_b32 s21, 1
    buffer_load_dwordx4 v[24:27], v10, s[40:43], s31 offen sc1
    buffer_load_dwordx4 v[28:31], v11, s[40:43], s31 offen sc1
    s_add_u32 s31, s31, 2048
    buffer_load_dwordx4 v[32:35], v10, s[40:43], s31 offen sc1
    buffer_load_dwordx4 v[36:39], v11, s[40:43], s31 offen sc1
    s_add_u32 s31, s31, 2048
    buffer_load_dwordx4 v[40:43], v10, s[40:43], s31 offen sc1
    buffer_load_dwordx4 v[44:47], v11, s[40:43], s31 offen sc1
    s_add_u32 s31, s31, 2048
    buffer_load_dwordx4 v[48:51], v10, s[40:43], s31 offen sc1
    buffer_load_dwordx4 v[52:55], v11, s[40:43], s31 offen sc1
    s_add_u32 s31, s31, 2048
    buffer_load_dwordx4 v[56:59], v10, s[40:43], s31 offen sc1
    buffer_load_dwordx4 v[60:63], v11, s[40:43], s31 offen sc1
    s_add_u32 s31, s31, 2048
    buffer_load_dwordx4 v[64:67], v10, s[40:43], s31 offen sc1
    buffer_load_dwordx4 v[68:71], v11, s[40:43], s31 offen sc1
    s_add_u32 s31, s31, 2048
    s_waitcnt vmcnt(19)
    s_branch L_f1pub
L_nopre:
    s_waitcnt vmcnt(3)
L_f1pub:
    s_cmp_lt_u32 s57, 12
    s_cselect_b32 s60, 1, 16
    v_mov_b32 v136, s60
    s_mov_b64 exec, 1
    ds_add_rtn_u32 v137, v1, v136 offset:8
    s_mov_b64 exec, -1
    s_lshl_b32 s59, s4, 3
    s_add_u32 s59, s59, s5
    s_lshl_b32 s59, s59, 7
    s_lshr_b32 s60, s60, 1
    s_add_u32 s59, s59, s60
    s_add_u32 s59, s59, 163840
    s_cmp_lt_u32 s5, 3
    s_cselect_b32 s63, 3, 1
    s_cmp_lt_u32 s57, 12
    s_cselect_b32 s63, 3, s63
    s_cselect_b32 s60, 0, 4
    s_waitcnt lgkmcnt(0)
    v_readfirstlane_b32 s62, v137
    s_nop 0
    s_lshr_b32 s62, s62, s60
    s_and_b32 s62, s62, 15
    s_cmp_lg_u32 s62, s63
    s_cbranch_scc1 L_nohflag
    v_mov_b64 v[136:137], s[52:53]
    s_mov_b64 exec, 1
    s_cmp_eq_u32 s25, 0
    s_cbranch_scc1 far_29
    buffer_store_dwordx2 v[136:137], off, s[40:43], s59
std_30:
    s_mov_b64 exec, -1
L_nohflag:
    s_cmp_eq_u32 s57, 10
    s_cbranch_scc1 L_f1loop
    v_bfe_u32 v6, v0, 2, 2
    v_lshrrev_b32 v13, 1, v6
    v_xor_b32 v13, s56, v13
    v_lshl_add_u32 v13, v13, 6, v4
    v_lshl_add_u32 v13, v6, 7, v13
    v_lshl_add_u32 v13, v5, 9, v13
    v_mov_b64 v[72:73], 0
    v_mov_b64 v[74:75], 0
    v_add_u32 v8, s35, v13
    v_xor_b32 v9, 64, v8
    s_setprio 0
    v_mfma_f32_32x32x16_bf16 v[88:103], v[72:75], v[72:75], 0
    s_setprio 3
    v_sub_u32 v78, 1, v5
    v_mov_b32 v77, 0
    v_mul_u32_u24 v78, 0x3f80, v78
    v_mov_b32 v79, 0
    s_mov_b32 s60, 0xffff0000
    s_waitcnt vmcnt(12)
    s_cmp_eq_u32 s21, 1
    s_cbranch_scc1 L_xin
    s_waitcnt vmcnt(0)
L_xin:
    v_permlane32_swap_b32 v80, v82
    v_permlane32_swap_b32 v81, v83
    v_permlane32_swap_b32 v84, v86
    v_permlane32_swap_b32 v85, v87
    v_lshlrev_b32 v136, 16, v80
    v_and_b32 v137, s60, v80
    v_lshlrev_b32 v138, 16, v81
    v_and_b32 v139, s60, v81
    v_lshlrev_b32 v140, 16, v82
    v_and_b32 v141, s60, v82
    v_lshlrev_b32 v142, 16, v83
    v_and_b32 v143, s60, v83
    v_lshlrev_b32 v144, 16, v84
    v_and_b32 v145, s60, v84
    v_lshlrev_b32 v146, 16, v85
    v_and_b32 v147, s60, v85
    v_lshlrev_b32 v148, 16, v86
    v_and_b32 v149, s60, v86
    v_lshlrev_b32 v150, 16, v87
    v_and_b32 v151, s60, v87
    s_nop 1
    s_setprio 0
    v_mfma_f32_32x32x8_bf16 v[136:151], v[76:77], v[78:79], v[136:151]
    s_setprio 3
    s_bfe_u32 s1, s18, 0x70008
    s_sub_u32 s12, s1, 6
    s_mov_b32 s44, s16
    s_mov_b32 s45, s17
    s_lshl_b32 s13, s54, 14
    s_lshl_b32 s26, s54, 17
    s_add_u32 s46, s26, 0x20000
    s_mov_b32 s47, 0x20000
    s_lshl_b32 s57, s5, 7
    s_add_u32 s26, s26, s57
    s_bitcmp1_b32 s18, 15
    s_cselect_b32 s27, 6, 12
    s_mov_b32 s0, 0
    s_mov_b32 s22, 1
    s_xor_b32 s10, s54, 1
    s_mov_b32 s11, s10
    s_mov_b32 s20, 1
    s_lshr_b32 s24, s10, 2
    s_lshl_b32 s24, s24, 1
    s_add_u32 s24, s24, 2
    s_add_u32 s24, s24, s52
    v_mov_b32 v20, s25
    s_mov_b32 s30, 0
    ds_write_b32 v1, v20 offset:48
    s_mul_i32 s57, s10, 9216
    s_add_u32 s57, s57, 114688
    v_add_u32 v17, s57, v2
    v_and_b32 v18, 31, v0
    v_lshl_add_u32 v18, v18, 2, s57
    v_and_b32 v16, 3, v0
    v_mul_u32_u24 v16, 2304, v16
    v_add_u32 v16, s57, v16
    s_bfe_u32 s58, s18, 0x80010
    ds_read_b32 v19, v16 offset:2300
    s_mov_b32 s20, 3
    s_waitcnt lgkmcnt(0)
    v_cmp_ne_u32 vcc, s24, v19
    s_nop 1
    s_cbranch_vccz L_fin
L_pre0:
    s_mov_b32 s20, 1
    s_cmp_eq_u32 s21, 1
    s_cbranch_scc1 L_filled
    s_mov_b32 s63, 0
poll_31:
    buffer_load_dwordx2 v[14:15], v12, s[40:43], s9 offen sc1
poll_31w:
    s_add_u32 s63, s63, 1
    s_waitcnt vmcnt(0)
    v_cmp_ne_u64 vcc, s[52:53], v[14:15]
    s_cmp_gt_u32 s63, 131072
    s_cbranch_scc1 polled_32
    s_cbranch_vccz polled_32
    s_sleep 2
    s_branch poll_31
polled_32:
    buffer_load_dwordx4 v[24:27], v10, s[40:43], s31 offen sc1
    buffer_load_dwordx4 v[28:31], v11, s[40:43], s31 offen sc1
    s_add_u32 s31, s31, 2048
    buffer_load_dwordx4 v[32:35], v10, s[40:43], s31 offen sc1
    buffer_load_dwordx4 v[36:39], v11, s[40:43], s31 offen sc1
    s_add_u32 s31, s31, 2048
    buffer_load_dwordx4 v[40:43], v10, s[40:43], s31 offen sc1
    buffer_load_dwordx4 v[44:47], v11, s[40:43], s31 offen sc1
    s_add_u32 s31, s31, 2048
    buffer_load_dwordx4 v[48:51], v10, s[40:43], s31 offen sc1
    buffer_load_dwordx4 v[52:55], v11, s[40:43], s31 offen sc1
    s_add_u32 s31, s31, 2048
    buffer_load_dwordx4 v[56:59], v10, s[40:43], s31 offen sc1
    buffer_load_dwordx4 v[60:63], v11, s[40:43], s31 offen sc1
    s_add_u32 s31, s31, 2048
    buffer_load_dwordx4 v[64:67], v10, s[40:43], s31 offen sc1
    buffer_load_dwordx4 v[68:71], v11, s[40:43], s31 offen sc1
    s_add_u32 s31, s31, 2048
L_filled:
    ds_read_b64_tr_b16 v[152:153], v8 offset:0
    ds_read_b64_tr_b16 v[154:155], v8 offset:1024
    ds_read_b64_tr_b16 v[156:157], v9 offset:0
    ds_read_b64_tr_b16 v[158:159], v9 offset:1024
    ds_read_b32 v19, v16 offset:2300
    s_add_u32 s9, s9, 8
    s_mov_b32 s21, 1
    s_cmp_eq_u32 s58, 0
    s_cselect_b32 s27, 255, s27
    s_waitcnt vmcnt(0)
.p2align 6
L_f2loop:
    s_waitcnt vmcnt(16) lgkmcnt(0)
    s_setprio 0
    v_mfma_f32_32x32x16_bf16 v[136:151], v[152:155], v[24:27], v[136:151]
    s_setprio 3
    ds_read_b64_tr_b16 v[160:161], v8 offset:2048
    ds_read_b64_tr_b16 v[162:163], v8 offset:3072
    ds_read_b64_tr_b16 v[164:165], v9 offset:2048
    ds_read_b64_tr_b16 v[166:167], v9 offset:3072
    s_setprio 0
    v_mfma_f32_32x32x16_bf16 v[104:119], v[156:159], v[24:27], v[104:119]
    s_setprio 3
    s_cmp_lg_u32 s21, 0
    s_cbranch_scc1 L_trip
L_tripped:
    s_add_u32 m0, s35, 0
    s_cmp_ge_u32 s0, s12
    s_cbranch_scc1 L_tail0
    buffer_load_dwordx4 v3, s[36:39], s19 offen lds
    buffer_load_dwordx4 v22, s[36:39], s19 offen offset:1024 lds
    s_setprio 0
    v_mfma_f32_32x32x16_bf16 v[120:135], v[152:155], v[28:31], v[120:135]
    s_setprio 3
    buffer_load_dwordx4 v[24:27], v10, s[40:43], s31 offen sc1
    s_add_u32 s19, s19, 16384
    s_add_u32 s0, s0, 1
    s_setprio 0
    v_mfma_f32_32x32x16_bf16 v[88:103], v[156:159], v[28:31], v[88:103]
    s_setprio 3
    buffer_load_dwordx4 v[28:31], v11, s[40:43], s31 offen sc1
    s_add_u32 s31, s31, 2048
L_next0:
    s_waitcnt vmcnt(16) lgkmcnt(0)
    s_setprio 0
    v_mfma_f32_32x32x16_bf16 v[136:151], v[160:163], v[32:35], v[136:151]
    s_setprio 3
    ds_read_b64_tr_b16 v[152:153], v8 offset:4096
    ds_read_b64_tr_b16 v[154:155], v8 offset:5120
    ds_read_b64_tr_b16 v[156:157], v9 offset:4096
    ds_read_b64_tr_b16 v[158:159], v9 offset:5120
    s_setprio 0
    v_mfma_f32_32x32x16_bf16 v[104:119], v[164:167], v[32:35], v[104:119]
    s_setprio 3
    s_add_u32 m0, s35, 2048
    s_cmp_ge_u32 s0, s12
    s_cbranch_scc1 L_tail1
    buffer_load_dwordx4 v3, s[36:39], s19 offen lds
    buffer_load_dwordx4 v22, s[36:39], s19 offen offset:1024 lds
    s_setprio 0
    v_mfma_f32_32x32x16_bf16 v[120:135], v[160:163], v[36:39], v[120:135]
    s_setprio 3
    buffer_load_dwordx4 v[32:35], v10, s[40:43], s31 offen sc1
    s_add_u32 s19, s19, 16384
    s_add_u32 s0, s0, 1
    s_setprio 0
    v_mfma_f32_32x32x16_bf16 v[88:103], v[164:167], v[36:39], v[88:103]
    s_setprio 3
    buffer_load_dwordx4 v[36:39], v11, s[40:43], s31 offen sc1
    s_add_u32 s31, s31, 2048
L_next1:
    s_waitcnt vmcnt(16) lgkmcnt(0)
    s_setprio 0
    v_mfma_f32_32x32x16_bf16 v[136:151], v[152:155], v[40:43], v[136:151]
    s_setprio 3
    ds_read_b64_tr_b16 v[160:161], v8 offset:6144
    ds_read_b64_tr_b16 v[162:163], v8 offset:7168
    ds_read_b64_tr_b16 v[164:165], v9 offset:6144
    ds_read_b64_tr_b16 v[166:167], v9 offset:7168
    s_setprio 0
    v_mfma_f32_32x32x16_bf16 v[104:119], v[156:159], v[40:43], v[104:119]
    s_setprio 3
    s_add_u32 m0, s35, 4096
    s_cmp_ge_u32 s0, s12
    s_cbranch_scc1 L_tail2
    buffer_load_dwordx4 v3, s[36:39], s19 offen lds
    buffer_load_dwordx4 v22, s[36:39], s19 offen offset:1024 lds
    s_setprio 0
    v_mfma_f32_32x32x16_bf16 v[120:135], v[152:155], v[44:47], v[120:135]
    s_setprio 3
    buffer_load_dwordx4 v[40:43], v10, s[40:43], s31 offen sc1
    s_add_u32 s19, s19, 16384
    s_add_u32 s0, s0, 1
    s_setprio 0
    v_mfma_f32_32x32x16_bf16 v[88:103], v[156:159], v[44:47], v[88:103]
    s_setprio 3
    buffer_load_dwordx4 v[44:47], v11, s[40:43], s31 offen sc1
    s_add_u32 s31, s31, 2048
L_next2:
    s_waitcnt vmcnt(16) lgkmcnt(0)
    s_setprio 0
    v_mfma_f32_32x32x16_bf16 v[136:151], v[160:163], v[48:51], v[136:151]
    s_setprio 3
    ds_read_b64_tr_b16 v[152:153], v8 offset:8192
    ds_read_b64_tr_b16 v[154:155], v8 offset:9216
    ds_read_b64_tr_b16 v[156:157], v9 offset:8192
    ds_read_b64_tr_b16 v[158:159], v9 offset:9216
    s_setprio 0
    v_mfma_f32_32x32x16_bf16 v[104:119], v[164:167], v[48:51], v[104:119]
    s_setprio 3
    s_add_u32 m0, s35, 6144
    s_cmp_ge_u32 s0, s12
    s_cbranch_scc1 L_tail3
    buffer_load_dwordx4 v3, s[36:39], s19 offen lds
    buffer_load_dwordx4 v22, s[36:39], s19 offen offset:1024 lds
    s_setprio 0
    v_mfma_f32_32x32x16_bf16 v[120:135], v[160:163], v[52:55], v[120:135]
    s_setprio 3
    buffer_load_dwordx4 v[48:51], v10, s[40:43], s31 offen sc1
    s_add_u32 s19, s19, 16384
    s_add_u32 s0, s0, 1
    s_setprio 0
    v_mfma_f32_32x32x16_bf16 v[88:103], v[164:167], v[52:55], v[88:103]
    s_setprio 3
    buffer_load_dwordx4 v[52:55], v11, s[40:43], s31 offen sc1
    s_add_u32 s31, s31, 2048
L_next3:
    s_waitcnt vmcnt(16) lgkmcnt(0)
    s_setprio 0
    v_mfma_f32_32x32x16_bf16 v[136:151], v[152:155], v[56:59], v[136:151]
    s_setprio 3
    ds_read_b64_tr_b16 v[160:161], v8 offset:10240
    ds_read_b64_tr_b16 v[162:163], v8 offset:11264
    ds_read_b64_tr_b16 v[164:165], v9 offset:10240
    ds_read_b64_tr_b16 v[166:167], v9 offset:11264
    s_setprio 0
    v_mfma_f32_32x32x16_bf16 v[104:119], v[156:159], v[56:59], v[104:119]
    s_setprio 3
    s_add_u32 m0, s35, 8192
    s_cmp_ge_u32 s0, s12
    s_cbranch_scc1 L_tail4
    buffer_load_dwordx4 v3, s[36:39], s19 offen lds
    buffer_load_dwordx4 v22, s[36:39], s19 offen offset:1024 lds
    s_setprio 0
    v_mfma_f32_32x32x16_bf16 v[120:135], v[152:155], v[60:63], v[120:135]
    s_setprio 3
    buffer_load_dwordx4 v[56:59], v10, s[40:43], s31 offen sc1
    s_add_u32 s19, s19, 16384
    s_add_u32 s0, s0, 1
    s_setprio 0
    v_mfma_f32_32x32x16_bf16 v[88:103], v[156:159], v[60:63], v[88:103]
    s_setprio 3
    buffer_load_dwordx4 v[60:63], v11, s[40:43], s31 offen sc1
    s_add_u32 s31, s31, 2048
L_next4:
    s_waitcnt vmcnt(16) lgkmcnt(0)
    s_setprio 0
    v_mfma_f32_32x32x16_bf16 v[136:151], v[160:163], v[64:67], v[136:151]
    s_setprio 3
    ds_read_b64_tr_b16 v[152:153], v8 offset:0
    ds_read_b64_tr_b16 v[154:155], v8 offset:1024
    ds_read_b64_tr_b16 v[156:157], v9 offset:0
    ds_read_b64_tr_b16 v[158:159], v9 offset:1024
    s_setprio 0
    v_mfma_f32_32x32x16_bf16 v[104:119], v[164:167], v[64:67], v[104:119]
    s_setprio 3
    ds_read_b32 v19, v16 offset:2300
    s_add_u32 m0, s35, 10240
    s_cmp_ge_u32 s0, s12
    s_cbranch_scc1 L_tail5
    buffer_load_dwordx4 v3, s[36:39], s19 offen lds
    buffer_load_dwordx4 v22, s[36:39], s19 offen offset:1024 lds
    s_setprio 0
    v_mfma_f32_32x32x16_bf16 v[120:135], v[160:163], v[68:71], v[120:135]
    s_setprio 3
    buffer_load_dwordx4 v[64:67], v10, s[40:43], s31 offen sc1
    s_add_u32 s19, s19, 16384
    s_add_u32 s0, s0, 1
    s_setprio 0
    v_mfma_f32_32x32x16_bf16 v[88:103], v[164:167], v[68:71], v[88:103]
    s_setprio 3
    buffer_load_dwordx4 v[68:71], v11, s[40:43], s31 offen sc1
    s_add_u32 s31, s31, 2048
    s_branch L_f2loop
L_next5:
L_tail0:
    s_setprio 0
    v_mfma_f32_32x32x16_bf16 v[120:135], v[152:155], v[28:31], v[120:135]
    s_setprio 3
    s_sub_u32 s57, s0, s12
    s_cmp_gt_u32 s57, 1
    s_cbranch_scc1 L_tw0
    s_call_b64 s[96:97], L_wo4
L_tw0:
    s_cmp_ge_u32 s26, s46
    s_cbranch_scc1 L_tx0
    s_mov_b32 m0, s13
    s_add_u32 s13, s13, 2048
    buffer_load_dwordx4 v3, s[44:47], s26 offen lds
    buffer_load_dwordx4 v22, s[44:47], s26 offen offset:1024 lds
    s_add_u32 s26, s26, 16384
    s_mov_b32 m0, s13
    s_add_u32 s13, s13, 2048
    buffer_load_dwordx4 v3, s[44:47], s26 offen lds
    buffer_load_dwordx4 v22, s[44:47], s26 offen offset:1024 lds
    s_add_u32 s26, s26, 16384
L_tx0:
    s_setprio 0
    v_mfma_f32_32x32x16_bf16 v[88:103], v[156:159], v[28:31], v[88:103]
    s_setprio 3
    s_cmp_lg_u32 s22, 0
    s_cbranch_scc1 L_to0
    s_add_u32 s57, s58, 20480
    buffer_load_dwordx4 v[64:67], v2, s[40:43], s57 offen offset:0 sc1
    buffer_load_dwordx4 v[68:71], v2, s[40:43], s57 offen offset:1024 sc1
L_to0:
    s_add_u32 s0, s0, 1
    s_cmp_lt_u32 s0, s1
    s_cbranch_scc1 L_next0
    s_cmp_lg_u32 s22, 0
    s_cbranch_scc1 L_f2done
    s_add_u32 s57, s58, 0
    buffer_load_dwordx4 v[24:27], v2, s[40:43], s57 offen offset:0 sc1
    buffer_load_dwordx4 v[28:31], v2, s[40:43], s57 offen offset:1024 sc1
    s_branch L_f2done
L_tail1:
    s_setprio 0
    v_mfma_f32_32x32x16_bf16 v[120:135], v[160:163], v[36:39], v[120:135]
    s_setprio 3
    s_sub_u32 s57, s0, s12
    s_cmp_gt_u32 s57, 1
    s_cbranch_scc1 L_tw1
    s_call_b64 s[96:97], L_wo4
L_tw1:
    s_cmp_ge_u32 s26, s46
    s_cbranch_scc1 L_tx1
    s_mov_b32 m0, s13
    s_add_u32 s13, s13, 2048
    buffer_load_dwordx4 v3, s[44:47], s26 offen lds
    buffer_load_dwordx4 v22, s[44:47], s26 offen offset:1024 lds
    s_add_u32 s26, s26, 16384
    s_mov_b32 m0, s13
    s_add_u32 s13, s13, 2048
    buffer_load_dwordx4 v3, s[44:47], s26 offen lds
    buffer_load_dwordx4 v22, s[44:47], s26 offen offset:1024 lds
    s_add_u32 s26, s26, 16384
L_tx1:
    s_setprio 0
    v_mfma_f32_32x32x16_bf16 v[88:103], v[164:167], v[36:39], v[88:103]
    s_setprio 3
    s_cmp_lg_u32 s22, 0
    s_cbranch_scc1 L_to1
    s_add_u32 s57, s58, 0
    buffer_load_dwordx4 v[24:27], v2, s[40:43], s57 offen offset:0 sc1
    buffer_load_dwordx4 v[28:31], v2, s[40:43], s57 offen offset:1024 sc1
L_to1:
    s_add_u32 s0, s0, 1
    s_cmp_lt_u32 s0, s1
    s_cbranch_scc1 L_next1
    s_cmp_lg_u32 s22, 0
    s_cbranch_scc1 L_f2done
    s_add_u32 s57, s58, 4096
    buffer_load_dwordx4 v[32:35], v2, s[40:43], s57 offen offset:0 sc1
    buffer_load_dwordx4 v[36:39], v2, s[40:43], s57 offen offset:1024 sc1
    s_branch L_f2done
L_tail2:
    s_setprio 0
    v_mfma_f32_32x32x16_bf16 v[120:135], v[152:155], v[44:47], v[120:135]
    s_setprio 3
    s_sub_u32 s57, s0, s12
    s_cmp_gt_u32 s57, 1
    s_cbranch_scc1 L_tw2
    s_call_b64 s[96:97], L_wo4
L_tw2:
    s_cmp_ge_u32 s26, s46
    s_cbranch_scc1 L_tx2
    s_mov_b32 m0, s13
    s_add_u32 s13, s13, 2048
    buffer_load_dwordx4 v3, s[44:47], s26 offen lds
    buffer_load_dwordx4 v22, s[44:47], s26 offen offset:1024 lds
    s_add_u32 s26, s26, 16384
    s_mov_b32 m0, s13
    s_add_u32 s13, s13, 2048
    buffer_load_dwordx4 v3, s[44:47], s26 offen lds
    buffer_load_dwordx4 v22, s[44:47], s26 offen offset:1024 lds
    s_add_u32 s26, s26, 16384
L_tx2:
    s_setprio 0
    v_mfma_f32_32x32x16_bf16 v[88:103], v[156:159], v[44:47], v[88:103]
    s_setprio 3
    s_cmp_lg_u32 s22, 0
    s_cbranch_scc1 L_to2
    s_add_u32 s57, s58, 4096
    buffer_load_dwordx4 v[32:35], v2, s[40:43], s57 offen offset:0 sc1
    buffer_load_dwordx4 v[36:39], v2, s[40:43], s57 offen offset:1024 sc1
L_to2:
    s_add_u32 s0, s0, 1
    s_cmp_lt_u32 s0, s1
    s_cbranch_scc1 L_next2
    s_cmp_lg_u32 s22, 0
    s_cbranch_scc1 L_f2done
    s_add_u32 s57, s58, 8192
    buffer_load_dwordx4 v[40:43], v2, s[40:43], s57 offen offset:0 sc1
    buffer_load_dwordx4 v[44:47], v2, s[40:43], s57 offen offset:1024 sc1
    s_branch L_f2done
L_tail3:
    s_setprio 0
    v_mfma_f32_32x32x16_bf16 v[120:135], v[160:163], v[52:55], v[120:135]
    s_setprio 3
    s_sub_u32 s57, s0, s12
    s_cmp_gt_u32 s57, 1
    s_cbranch_scc1 L_tw3
    s_call_b64 s[96:97], L_wo4
L_tw3:
    s_cmp_ge_u32 s26, s46
    s_cbranch_scc1 L_tx3
    s_mov_b32 m0, s13
    s_add_u32 s13, s13, 2048
    buffer_load_dwordx4 v3, s[44:47], s26 offen lds
    buffer_load_dwordx4 v22, s[44:47], s26 offen offset:1024 lds
    s_add_u32 s26, s26, 16384
    s_mov_b32 m0, s13
    s_add_u32 s13, s13, 2048
    buffer_load_dwordx4 v3, s[44:47], s26 offen lds
    buffer_load_dwordx4 v22, s[44:47], s26 offen offset:1024 lds
    s_add_u32 s26, s26, 16384
L_tx3:
    s_setprio 0
    v_mfma_f32_32x32x16_bf16 v[88:103], v[164:167], v[52:55], v[88:103]
    s_setprio 3
    s_cmp_lg_u32 s22, 0
    s_cbranch_scc1 L_to3
    s_add_u32 s57, s58, 8192
    buffer_load_dwordx4 v[40:43], v2, s[40:43], s57 offen offset:0 sc1
    buffer_load_dwordx4 v[44:47], v2, s[40:43], s57 offen offset:1024 sc1
L_to3:
    s_add_u32 s0, s0, 1
    s_cmp_lt_u32 s0, s1
    s_cbranch_scc1 L_next3
    s_cmp_lg_u32 s22, 0
    s_cbranch_scc1 L_f2done
    s_add_u32 s57, s58, 12288
    buffer_load_dwordx4 v[48:51], v2, s[40:43], s57 offen offset:0 sc1
    buffer_load_dwordx4 v[52:55], v2, s[40:43], s57 offen offset:1024 sc1
    s_branch L_f2done
L_tail4:
    s_setprio 0
    v_mfma_f32_32x32x16_bf16 v[120:135], v[152:155], v[60:63], v[120:135]
    s_setprio 3
    s_sub_u32 s57, s0, s12
    s_cmp_gt_u32 s57, 1
    s_cbranch_scc1 L_tw4
    s_call_b64 s[96:97], L_wo4
L_tw4:
    s_cmp_ge_u32 s26, s46
    s_cbranch_scc1 L_tx4
    s_mov_b32 m0, s13
    s_add_u32 s13, s13, 2048
    buffer_load_dwordx4 v3, s[44:47], s26 offen lds
    buffer_load_dwordx4 v22, s[44:47], s26 offen offset:1024 lds
    s_add_u32 s26, s26, 16384
    s_mov_b32 m0, s13
    s_add_u32 s13, s13, 2048
    buffer_load_dwordx4 v3, s[44:47], s26 offen lds
    buffer_load_dwordx4 v22, s[44:47], s26 offen offset:1024 lds
    s_add_u32 s26, s26, 16384
L_tx4:
    s_setprio 0
    v_mfma_f32_32x32x16_bf16 v[88:103], v[156:159], v[60:63], v[88:103]
    s_setprio 3
    s_cmp_lg_u32 s22, 0
    s_cbranch_scc1 L_to4
    s_add_u32 s57, s58, 12288
    buffer_load_dwordx4 v[48:51], v2, s[40:43], s57 offen offset:0 sc1
    buffer_load_dwordx4 v[52:55], v2, s[40:43], s57 offen offset:1024 sc1
L_to4:
    s_add_u32 s0, s0, 1
    s_cmp_lt_u32 s0, s1
    s_cbranch_scc1 L_next4
    s_cmp_lg_u32 s22, 0
    s_cbranch_scc1 L_f2done
    s_add_u32 s57, s58, 16384
    buffer_load_dwordx4 v[56:59], v2, s[40:43], s57 offen offset:0 sc1
    buffer_load_dwordx4 v[60:63], v2, s[40:43], s57 offen offset:1024 sc1
    s_branch L_f2done
L_tail5:
    s_setprio 0
    v_mfma_f32_32x32x16_bf16 v[120:135], v[160:163], v[68:71], v[120:135]
    s_setprio 3
    s_sub_u32 s57, s0, s12
    s_cmp_gt_u32 s57, 1
    s_cbranch_scc1 L_tw5
    s_call_b64 s[96:97], L_wo4
L_tw5:
    s_cmp_ge_u32 s26, s46
    s_cbranch_scc1 L_tx5
    s_mov_b32 m0, s13
    s_add_u32 s13, s13, 2048
    buffer_load_dwordx4 v3, s[44:47], s26 offen lds
    buffer_load_dwordx4 v22, s[44:47], s26 offen offset:1024 lds
    s_add_u32 s26, s26, 16384
    s_mov_b32 m0, s13
    s_add_u32 s13, s13, 2048
    buffer_load_dwordx4 v3, s[44:47], s26 offen lds
    buffer_load_dwordx4 v22, s[44:47], s26 offen offset:1024 lds
    s_add_u32 s26, s26, 16384
L_tx5:
    s_setprio 0
    v_mfma_f32_32x32x16_bf16 v[88:103], v[164:167], v[68:71], v[88:103]
    s_setprio 3
    s_cmp_lg_u32 s22, 0
    s_cbranch_scc1 L_to5
    s_add_u32 s57, s58, 16384
    buffer_load_dwordx4 v[56:59], v2, s[40:43], s57 offen offset:0 sc1
    buffer_load_dwordx4 v[60:63], v2, s[40:43], s57 offen offset:1024 sc1
L_to5:
    s_add_u32 s0, s0, 1
    s_cmp_lt_u32 s0, s1
    s_cbranch_scc1 L_f2loop
    s_cmp_lg_u32 s22, 0
    s_cbranch_scc1 L_f2done
    s_add_u32 s57, s58, 20480
    buffer_load_dwordx4 v[64:67], v2, s[40:43], s57 offen offset:0 sc1
    buffer_load_dwordx4 v[68:71], v2, s[40:43], s57 offen offset:1024 sc1
    s_branch L_f2done
L_wo4:
    s_cmp_eq_u32 s57, 0
    s_cbranch_scc1 L_wo4a
    s_waitcnt vmcnt(4)
    v_cmp_ne_u64 vcc, s[52:53], v[14:15]
    s_nop 1
    s_and_b32 s22, vcc_lo, 0xffff
    s_cmp_lt_u32 s10, 8
    s_cselect_b32 s22, 1, s22
    s_setpc_b64 s[96:97]
L_wo4a:
    s_lshl_b32 s19, s4, 10
    s_lshl_b32 s57, s55, 3
    s_add_u32 s19, s19, s57
    s_add_u32 s19, s19, 196608
    v_and_b32 v20, 24, v0
    v_lshl_add_u32 v12, v20, 1, v12
    s_lshl_b32 s58, s4, 1
    buffer_load_dwordx2 v[14:15], v12, s[40:43], s19 offen sc1
    s_add_u32 s58, s58, s55
    s_lshl_b32 s58, s58, 15
    s_add_u32 s58, s58, 262144
    s_cmp_lt_u32 s5, 3
    s_cselect_b32 s60, 68, 36
    s_mov_b32 s63, 0
spin_33:
    ds_read_b32 v20, v1 offset:8
    s_add_u32 s63, s63, 1
    s_waitcnt lgkmcnt(0)
    v_readfirstlane_b32 s62, v20
    s_cmp_gt_u32 s63, 131072
    s_cbranch_scc1 spun_34
    s_cmp_ge_u32 s62, s60
    s_cbranch_scc1 spun_34
    s_sleep 1
    s_branch spin_33
spun_34:
    s_setpc_b64 s[96:97]
L_f2done:
    v_add_u32 v23, s35, v2
    s_mov_b32 s0, 0
    s_mov_b32 s20, 0
    s_mov_b32 s23, 0
    s_mov_b32 s48, s28
    s_mov_b32 s49, s29
    s_mov_b32 s50, 2097152
    s_mov_b32 s51, 0x20000
    s_waitcnt lgkmcnt(0)
    ds_write_b128 v23, v[104:107] offset:0
    ds_write_b128 v23, v[108:111] offset:1024
    ds_write_b128 v23, v[112:115] offset:2048
    ds_write_b128 v23, v[116:119] offset:3072
    ds_write_b128 v23, v[120:123] offset:4096
    ds_write_b128 v23, v[124:127] offset:5120
    ds_write_b128 v23, v[128:131] offset:6144
    ds_write_b128 v23, v[132:135] offset:7168
    ds_write_b128 v23, v[88:91] offset:8192
    ds_write_b128 v23, v[92:95] offset:9216
    ds_write_b128 v23, v[96:99] offset:10240
    ds_write_b128 v23, v[100:103] offset:11264
    s_cmp_lg_u32 s22, 0
    s_cbranch_scc1 L_slow
    s_add_u32 s57, s58, 24576
    buffer_load_dwordx4 v[152:155], v2, s[40:43], s57 offen offset:0 sc1
    buffer_load_dwordx4 v[156:159], v2, s[40:43], s57 offen offset:1024 sc1
    s_add_u32 s57, s58, 28672
    buffer_load_dwordx4 v[160:163], v2, s[40:43], s57 offen offset:0 sc1
    buffer_load_dwordx4 v[164:167], v2, s[40:43], s57 offen offset:1024 sc1
    s_waitcnt vmcnt(12)
L_slowr:
    s_cmp_ge_u32 s11, s10
    s_cbranch_scc1 L_nopf
    s_lshl_b32 s57, s4, 3
    s_add_u32 s57, s57, s5
    s_lshl_b32 s57, s57, 4
    s_add_u32 s57, s57, s11
    s_lshl_b32 s57, s57, 3
    s_add_u32 s57, s57, 196608
    s_mov_b32 s11, s10
    v_mov_b64 v[20:21], s[52:53]
    s_mov_b64 exec, 1
    s_cmp_eq_u32 s25, 0
    s_cbranch_scc1 far_35
    buffer_store_dwordx2 v[20:21], off, s[40:43], s57
std_36:
    s_mov_b64 exec, -1
L_nopf:
    v_mov_b32 v23, 1
    s_mov_b64 exec, 1
    ds_add_u32 v1, v23 offset:12
    s_mov_b64 exec, -1
L_red:
    s_mov_b32 s63, 0
spin_37:
    ds_read_b32 v14, v1 offset:12
    s_add_u32 s63, s63, 1
    s_waitcnt lgkmcnt(0)
    v_readfirstlane_b32 s62, v14
    s_cmp_gt_u32 s63, 131072
    s_cbranch_scc1 spun_38
    s_cmp_ge_u32 s62, 4
    s_cbranch_scc1 spun_38
    s_sleep 1
    s_branch spin_37
spun_38:
    s_xor_b32 s57, s54, 1
    s_mul_i32 s57, s57, 12288
    s_add_u32 s57, s57, 65536
    v_add_u32 v14, s57, v2
    ds_read_b128 v[104:107], v14 offset:0
    ds_read_b128 v[108:111], v14 offset:1024
    ds_read_b128 v[112:115], v14 offset:2048
    ds_read_b128 v[116:119], v14 offset:3072
    s_xor_b32 s57, s54, 2
    s_mul_i32 s57, s57, 12288
    s_add_u32 s57, s57, 65536
    v_add_u32 v14, s57, v2
    ds_read_b128 v[120:123], v14 offset:4096
    ds_read_b128 v[124:127], v14 offset:5120
    ds_read_b128 v[128:131], v14 offset:6144
    ds_read_b128 v[132:135], v14 offset:7168
    s_xor_b32 s57, s54, 3
    s_mul_i32 s57, s57, 12288
    s_add_u32 s57, s57, 65536
    v_add_u32 v14, s57, v2
    ds_read_b128 v[88:91], v14 offset:8192
    ds_read_b128 v[92:95], v14 offset:9216
    ds_read_b128 v[96:99], v14 offset:10240
    ds_read_b128 v[100:103], v14 offset:11264
    buffer_load_dwordx2 v[14:15], v12, s[40:43], s19 offen sc1
    s_waitcnt lgkmcnt(8)
    v_pk_add_f32 v[136:137], v[136:137], v[104:105]
    v_pk_add_f32 v[138:139], v[138:139], v[106:107]
    v_pk_add_f32 v[140:141], v[140:141], v[108:109]
    v_pk_add_f32 v[142:143], v[142:143], v[110:111]
    v_pk_add_f32 v[144:145], v[144:145], v[112:113]
    v_pk_add_f32 v[146:147], v[146:147], v[114:115]
    v_pk_add_f32 v[148:149], v[148:149], v[116:117]
    v_pk_add_f32 v[150:151], v[150:151], v[118:119]
    s_waitcnt lgkmcnt(4)
    v_pk_add_f32 v[136:137], v[136:137], v[120:121]
    v_pk_add_f32 v[138:139], v[138:139], v[122:123]
    v_pk_add_f32 v[140:141], v[140:141], v[124:125]
    v_pk_add_f32 v[142:143], v[142:143], v[126:127]
    v_pk_add_f32 v[144:145], v[144:145], v[128:129]
    v_pk_add_f32 v[146:147], v[146:147], v[130:131]
    v_pk_add_f32 v[148:149], v[148:149], v[132:133]
    v_pk_add_f32 v[150:151], v[150:151], v[134:135]
    s_waitcnt lgkmcnt(0)
    v_pk_add_f32 v[136:137], v[136:137], v[88:89]
    v_pk_add_f32 v[138:139], v[138:139], v[90:91]
    v_pk_add_f32 v[140:141], v[140:141], v[92:93]
    v_pk_add_f32 v[142:143], v[142:143], v[94:95]
    v_pk_add_f32 v[144:145], v[144:145], v[96:97]
    v_pk_add_f32 v[146:147], v[146:147], v[98:99]
    v_pk_add_f32 v[148:149], v[148:149], v[100:101]
    v_pk_add_f32 v[150:151], v[150:151], v[102:103]
    s_cmp_eq_u32 s22, 0
    s_cbranch_scc1 L_pair
    s_cmp_lt_u32 s10, 8
    s_cbranch_scc1 L_own
L_ev:
    s_cmp_ge_u32 s11, s10
    s_cbranch_scc1 L_evf
    s_lshl_b32 s57, s4, 3
    s_add_u32 s57, s57, s5
    s_lshl_b32 s57, s57, 4
    s_add_u32 s57, s57, s11
    s_lshl_b32 s57, s57, 3
    s_add_u32 s57, s57, 196608
    s_mov_b32 s11, s10
    s_waitcnt vmcnt(0)
    v_mov_b64 v[14:15], s[52:53]
    s_mov_b64 exec, 1
    s_cmp_eq_u32 s25, 0
    s_cbranch_scc1 far_39
    buffer_store_dwordx2 v[14:15], off, s[40:43], s57
std_40:
    s_mov_b64 exec, -1
L_evf:
    s_cmp_lg_u32 s0, 0
    s_cbranch_scc1 L_gdone
L_p01:
    buffer_load_dwordx2 v[14:15], v12, s[40:43], s19 offen sc1
L_p01w:
    s_add_u32 s23, s23, 1
    s_cmp_gt_u32 s23, 131072
    s_cbranch_scc1 L_gdone
    s_waitcnt vmcnt(0)
    v_cmp_ne_u64 vcc, s[52:53], v[14:15]
    s_nop 1
    s_bfe_u32 s57, vcc_lo, 1048576
    s_cbranch_scc1 L_p01
    s_mov_b32 s57, s58
    buffer_load_dwordx4 v[24:27], v2, s[40:43], s57 offen offset:0 sc1
    buffer_load_dwordx4 v[28:31], v2, s[40:43], s57 offen offset:1024 sc1
    s_add_u32 s57, s57, 4096
    buffer_load_dwordx4 v[32:35], v2, s[40:43], s57 offen offset:0 sc1
    buffer_load_dwordx4 v[36:39], v2, s[40:43], s57 offen offset:1024 sc1
    s_add_u32 s57, s57, 4096
    buffer_load_dwordx4 v[40:43], v2, s[40:43], s57 offen offset:0 sc1
    buffer_load_dwordx4 v[44:47], v2, s[40:43], s57 offen offset:1024 sc1
    s_add_u32 s57, s57, 4096
    buffer_load_dwordx4 v[48:51], v2, s[40:43], s57 offen offset:0 sc1
    buffer_load_dwordx4 v[52:55], v2, s[40:43], s57 offen offset:1024 sc1
    s_add_u32 s57, s57, 4096
    buffer_load_dwordx4 v[56:59], v2, s[40:43], s57 offen offset:0 sc1
    buffer_load_dwordx4 v[60:63], v2, s[40:43], s57 offen offset:1024 sc1
    s_add_u32 s57, s57, 4096
    buffer_load_dwordx4 v[64:67], v2, s[40:43], s57 offen offset:0 sc1
    buffer_load_dwordx4 v[68:71], v2, s[40:43], s57 offen offset:1024 sc1
    s_add_u32 s57, s57, 4096
    buffer_load_dwordx4 v[152:155], v2, s[40:43], s57 offen offset:0 sc1
    buffer_load_dwordx4 v[156:159], v2, s[40:43], s57 offen offset:1024 sc1
    s_add_u32 s57, s57, 4096
    buffer_load_dwordx4 v[160:163], v2, s[40:43], s57 offen offset:0 sc1
    buffer_load_dwordx4 v[164:167], v2, s[40:43], s57 offen offset:1024 sc1
L_pair:
    ds_read_b64_tr_b16 v[88:89], v13 offset:0
    ds_read_b64_tr_b16 v[90:91], v13 offset:1024
    ds_read_b64_tr_b16 v[92:93], v13 offset:8192
    ds_read_b64_tr_b16 v[94:95], v13 offset:9216
    ds_read_b64_tr_b16 v[96:97], v13 offset:16384
    ds_read_b64_tr_b16 v[98:99], v13 offset:17408
    ds_read_b64_tr_b16 v[100:101], v13 offset:24576
    ds_read_b64_tr_b16 v[102:103], v13 offset:25600
    ds_read_b64_tr_b16 v[104:105], v13 offset:32768
    ds_read_b64_tr_b16 v[106:107], v13 offset:33792
    ds_read_b64_tr_b16 v[108:109], v13 offset:40960
    ds_read_b64_tr_b16 v[110:111], v13 offset:41984
    ds_read_b64_tr_b16 v[112:113], v13 offset:49152
    ds_read_b64_tr_b16 v[114:115], v13 offset:50176
    ds_read_b64_tr_b16 v[116:117], v13 offset:57344
    ds_read_b64_tr_b16 v[118:119], v13 offset:58368
    ds_read_b64_tr_b16 v[120:121], v13 offset:2048
    ds_read_b64_tr_b16 v[122:123], v13 offset:3072
    ds_read_b64_tr_b16 v[124:125], v13 offset:10240
    ds_read_b64_tr_b16 v[126:127], v13 offset:11264
    ds_read_b64_tr_b16 v[128:129], v13 offset:18432
    ds_read_b64_tr_b16 v[130:131], v13 offset:19456
    ds_read_b64_tr_b16 v[132:133], v13 offset:26624
    ds_read_b64_tr_b16 v[134:135], v13 offset:27648
    ds_read_b64_tr_b16 v[72:73], v13 offset:34816
    ds_read_b64_tr_b16 v[74:75], v13 offset:35840
    ds_read_b64_tr_b16 v[76:77], v13 offset:43008
    ds_read_b64_tr_b16 v[78:79], v13 offset:44032
    ds_read_b64_tr_b16 v[80:81], v13 offset:51200
    ds_read_b64_tr_b16 v[82:83], v13 offset:52224
    ds_read_b64_tr_b16 v[84:85], v13 offset:59392
    ds_read_b64_tr_b16 v[86:87], v13 offset:60416
    s_waitcnt vmcnt(1)
    s_waitcnt lgkmcnt(15)
    s_setprio 0
    v_mfma_f32_32x32x16_bf16 v[136:151], v[88:91], v[24:27], v[136:151]
    v_mfma_f32_32x32x16_bf16 v[136:151], v[92:95], v[32:35], v[136:151]
    v_mfma_f32_32x32x16_bf16 v[136:151], v[96:99], v[40:43], v[136:151]
    v_mfma_f32_32x32x16_bf16 v[136:151], v[100:103], v[48:51], v[136:151]
    v_mfma_f32_32x32x16_bf16 v[136:151], v[104:107], v[56:59], v[136:151]
    v_mfma_f32_32x32x16_bf16 v[136:151], v[108:111], v[64:67], v[136:151]
    v_mfma_f32_32x32x16_bf16 v[136:151], v[112:115], v[152:155], v[136:151]
    v_mfma_f32_32x32x16_bf16 v[136:151], v[116:119], v[160:163], v[136:151]
    s_setprio 3
    s_waitcnt vmcnt(0) lgkmcnt(0)
    v_cmp_ne_u64 vcc, s[52:53], v[14:15]
    ds_read_b64_tr_b16 v[88:89], v13 offset:4096
    ds_read_b64_tr_b16 v[90:91], v13 offset:5120
    ds_read_b64_tr_b16 v[92:93], v13 offset:12288
    ds_read_b64_tr_b16 v[94:95], v13 offset:13312
    ds_read_b64_tr_b16 v[96:97], v13 offset:20480
    ds_read_b64_tr_b16 v[98:99], v13 offset:21504
    ds_read_b64_tr_b16 v[100:101], v13 offset:28672
    ds_read_b64_tr_b16 v[102:103], v13 offset:29696
    ds_read_b64_tr_b16 v[104:105], v13 offset:36864
    ds_read_b64_tr_b16 v[106:107], v13 offset:37888
    ds_read_b64_tr_b16 v[108:109], v13 offset:45056
    ds_read_b64_tr_b16 v[110:111], v13 offset:46080
    ds_read_b64_tr_b16 v[112:113], v13 offset:53248
    ds_read_b64_tr_b16 v[114:115], v13 offset:54272
    ds_read_b64_tr_b16 v[116:117], v13 offset:61440
    ds_read_b64_tr_b16 v[118:119], v13 offset:62464
    s_bfe_u32 s22, vcc_lo, 0x80010
    s_cbranch_scc1 L_no2
    s_mov_b32 s57, s58
    buffer_load_dwordx4 v[24:27], v2, s[40:43], s57 offen offset:2048 sc1
    s_add_u32 s57, s57, 4096
    buffer_load_dwordx4 v[32:35], v2, s[40:43], s57 offen offset:2048 sc1
    s_add_u32 s57, s57, 4096
    buffer_load_dwordx4 v[40:43], v2, s[40:43], s57 offen offset:2048 sc1
    s_add_u32 s57, s57, 4096
    buffer_load_dwordx4 v[48:51], v2, s[40:43], s57 offen offset:2048 sc1
    s_add_u32 s57, s57, 4096
    buffer_load_dwordx4 v[56:59], v2, s[40:43], s57 offen offset:2048 sc1
    s_add_u32 s57, s57, 4096
    buffer_load_dwordx4 v[64:67], v2, s[40:43], s57 offen offset:2048 sc1
    s_add_u32 s57, s57, 4096
    buffer_load_dwordx4 v[152:155], v2, s[40:43], s57 offen offset:2048 sc1
    s_add_u32 s57, s57, 4096
    buffer_load_dwordx4 v[160:163], v2, s[40:43], s57 offen offset:2048 sc1
L_no2:
    buffer_load_dwordx2 v[14:15], v12, s[40:43], s19 offen sc1
    s_waitcnt lgkmcnt(15)
    s_setprio 0
    v_mfma_f32_32x32x16_bf16 v[136:151], v[120:123], v[28:31], v[136:151]
    v_mfma_f32_32x32x16_bf16 v[136:151], v[124:127], v[36:39], v[136:151]
    v_mfma_f32_32x32x16_bf16 v[136:151], v[128:131], v[44:47], v[136:151]
    v_mfma_f32_32x32x16_bf16 v[136:151], v[132:135], v[52:55], v[136:151]
    v_mfma_f32_32x32x16_bf16 v[136:151], v[72:75], v[60:63], v[136:151]
    v_mfma_f32_32x32x16_bf16 v[136:151], v[76:79], v[68:71], v[136:151]
    v_mfma_f32_32x32x16_bf16 v[136:151], v[80:83], v[156:159], v[136:151]
    v_mfma_f32_32x32x16_bf16 v[136:151], v[84:87], v[164:167], v[136:151]
    s_setprio 3
    ds_read_b64_tr_b16 v[120:121], v13 offset:6144
    ds_read_b64_tr_b16 v[122:123], v13 offset:7168
    ds_read_b64_tr_b16 v[124:125], v13 offset:14336
    ds_read_b64_tr_b16 v[126:127], v13 offset:15360
    ds_read_b64_tr_b16 v[128:129], v13 offset:22528
    ds_read_b64_tr_b16 v[130:131], v13 offset:23552
    ds_read_b64_tr_b16 v[132:133], v13 offset:30720
    ds_read_b64_tr_b16 v[134:135], v13 offset:31744
    ds_read_b64_tr_b16 v[72:73], v13 offset:38912
    ds_read_b64_tr_b16 v[74:75], v13 offset:39936
    ds_read_b64_tr_b16 v[76:77], v13 offset:47104
    ds_read_b64_tr_b16 v[78:79], v13 offset:48128
    ds_read_b64_tr_b16 v[80:81], v13 offset:55296
    ds_read_b64_tr_b16 v[82:83], v13 offset:56320
    ds_read_b64_tr_b16 v[84:85], v13 offset:63488
    ds_read_b64_tr_b16 v[86:87], v13 offset:64512
    s_cmp_eq_u32 s22, 0
    s_cbranch_scc1 L_have2
    s_branch L_p2w
L_p2:
    buffer_load_dwordx2 v[14:15], v12, s[40:43], s19 offen sc1
L_p2w:
    s_add_u32 s23, s23, 1
    s_cmp_gt_u32 s23, 131072
    s_cbranch_scc1 L_gdone
    s_waitcnt vmcnt(0)
    v_cmp_ne_u64 vcc, s[52:53], v[14:15]
    s_nop 1
    s_bfe_u32 s57, vcc_lo, 524304
    s_cbranch_scc1 L_p2
    s_mov_b32 s57, s58
    buffer_load_dwordx4 v[24:27], v2, s[40:43], s57 offen offset:2048 sc1
    s_add_u32 s57, s57, 4096
    buffer_load_dwordx4 v[32:35], v2, s[40:43], s57 offen offset:2048 sc1
    s_add_u32 s57, s57, 4096
    buffer_load_dwordx4 v[40:43], v2, s[40:43], s57 offen offset:2048 sc1
    s_add_u32 s57, s57, 4096
    buffer_load_dwordx4 v[48:51], v2, s[40:43], s57 offen offset:2048 sc1
    s_add_u32 s57, s57, 4096
    buffer_load_dwordx4 v[56:59], v2, s[40:43], s57 offen offset:2048 sc1
    s_add_u32 s57, s57, 4096
    buffer_load_dwordx4 v[64:67], v2, s[40:43], s57 offen offset:2048 sc1
    s_add_u32 s57, s57, 4096
    buffer_load_dwordx4 v[152:155], v2, s[40:43], s57 offen offset:2048 sc1
    s_add_u32 s57, s57, 4096
    buffer_load_dwordx4 v[160:163], v2, s[40:43], s57 offen offset:2048 sc1
    s_lshr_b32 s57, vcc_lo, 24
    s_cbranch_scc0 L_l3
    buffer_load_dwordx2 v[14:15], v12, s[40:43], s19 offen sc1
L_m2:
    s_waitcnt lgkmcnt(0)
    s_setprio 0
    s_waitcnt vmcnt(8)
    v_mfma_f32_32x32x16_bf16 v[136:151], v[88:91], v[24:27], v[136:151]
    s_waitcnt vmcnt(7)
    v_mfma_f32_32x32x16_bf16 v[136:151], v[92:95], v[32:35], v[136:151]
    s_waitcnt vmcnt(6)
    v_mfma_f32_32x32x16_bf16 v[136:151], v[96:99], v[40:43], v[136:151]
    s_waitcnt vmcnt(5)
    v_mfma_f32_32x32x16_bf16 v[136:151], v[100:103], v[48:51], v[136:151]
    s_waitcnt vmcnt(4)
    v_mfma_f32_32x32x16_bf16 v[136:151], v[104:107], v[56:59], v[136:151]
    s_waitcnt vmcnt(3)
    v_mfma_f32_32x32x16_bf16 v[136:151], v[108:111], v[64:67], v[136:151]
    s_waitcnt vmcnt(2)
    v_mfma_f32_32x32x16_bf16 v[136:151], v[112:115], v[152:155], v[136:151]
    s_waitcnt vmcnt(1)
    v_mfma_f32_32x32x16_bf16 v[136:151], v[116:119], v[160:163], v[136:151]
    s_setprio 3
    s_branch L_p3w
L_p3:
    buffer_load_dwordx2 v[14:15], v12, s[40:43], s19 offen sc1
L_p3w:
    s_add_u32 s23, s23, 1
    s_cmp_gt_u32 s23, 131072
    s_cbranch_scc1 L_gdone
    s_waitcnt vmcnt(0)
    v_cmp_ne_u64 vcc, s[52:53], v[14:15]
    s_nop 1
    s_bfe_u32 s57, vcc_lo, 524312
    s_cbranch_scc1 L_p3
    s_mov_b32 s57, s58
    buffer_load_dwordx4 v[28:31], v2, s[40:43], s57 offen offset:3072 sc1
    s_add_u32 s57, s57, 4096
    buffer_load_dwordx4 v[36:39], v2, s[40:43], s57 offen offset:3072 sc1
    s_add_u32 s57, s57, 4096
    buffer_load_dwordx4 v[44:47], v2, s[40:43], s57 offen offset:3072 sc1
    s_add_u32 s57, s57, 4096
    buffer_load_dwordx4 v[52:55], v2, s[40:43], s57 offen offset:3072 sc1
    s_add_u32 s57, s57, 4096
    buffer_load_dwordx4 v[60:63], v2, s[40:43], s57 offen offset:3072 sc1
    s_add_u32 s57, s57, 4096
    buffer_load_dwordx4 v[68:71], v2, s[40:43], s57 offen offset:3072 sc1
    s_add_u32 s57, s57, 4096
    buffer_load_dwordx4 v[156:159], v2, s[40:43], s57 offen offset:3072 sc1
    s_add_u32 s57, s57, 4096
    buffer_load_dwordx4 v[164:167], v2, s[40:43], s57 offen offset:3072 sc1
    s_branch L_m3
L_have2:
    s_waitcnt vmcnt(0)
    v_cmp_ne_u64 vcc, s[52:53], v[14:15]
    s_nop 1
    s_lshr_b32 s57, vcc_lo, 24
    s_cbranch_scc0 L_l3
    buffer_load_dwordx2 v[14:15], v12, s[40:43], s19 offen sc1
    s_branch L_m2
L_l3:
    s_mov_b32 s57, s58
    buffer_load_dwordx4 v[28:31], v2, s[40:43], s57 offen offset:3072 sc1
    s_add_u32 s57, s57, 4096
    buffer_load_dwordx4 v[36:39], v2, s[40:43], s57 offen offset:3072 sc1
    s_add_u32 s57, s57, 4096
    buffer_load_dwordx4 v[44:47], v2, s[40:43], s57 offen offset:3072 sc1
    s_add_u32 s57, s57, 4096
    buffer_load_dwordx4 v[52:55], v2, s[40:43], s57 offen offset:3072 sc1
    s_add_u32 s57, s57, 4096
    buffer_load_dwordx4 v[60:63], v2, s[40:43], s57 offen offset:3072 sc1
    s_add_u32 s57, s57, 4096
    buffer_load_dwordx4 v[68:71], v2, s[40:43], s57 offen offset:3072 sc1
    s_add_u32 s57, s57, 4096
    buffer_load_dwordx4 v[156:159], v2, s[40:43], s57 offen offset:3072 sc1
    s_add_u32 s57, s57, 4096
    buffer_load_dwordx4 v[164:167], v2, s[40:43], s57 offen offset:3072 sc1
    s_waitcnt lgkmcnt(0)
    s_waitcnt vmcnt(15)
    v_mfma_f32_32x32x16_bf16 v[136:151], v[88:91], v[24:27], v[136:151]
    s_waitcnt vmcnt(14)
    v_mfma_f32_32x32x16_bf16 v[136:151], v[92:95], v[32:35], v[136:151]
    s_waitcnt vmcnt(13)
    v_mfma_f32_32x32x16_bf16 v[136:151], v[96:99], v[40:43], v[136:151]
    s_waitcnt vmcnt(12)
    v_mfma_f32_32x32x16_bf16 v[136:151], v[100:103], v[48:51], v[136:151]
    s_waitcnt vmcnt(11)
    v_mfma_f32_32x32x16_bf16 v[136:151], v[104:107], v[56:59], v[136:151]
    s_waitcnt vmcnt(10)
    v_mfma_f32_32x32x16_bf16 v[136:151], v[108:111], v[64:67], v[136:151]
    s_waitcnt vmcnt(9)
    v_mfma_f32_32x32x16_bf16 v[136:151], v[112:115], v[152:155], v[136:151]
    s_waitcnt vmcnt(8)
    v_mfma_f32_32x32x16_bf16 v[136:151], v[116:119], v[160:163], v[136:151]
L_m3:
    s_waitcnt lgkmcnt(0)
    s_waitcnt vmcnt(7)
    v_mfma_f32_32x32x16_bf16 v[136:151], v[120:123], v[28:31], v[136:151]
    s_waitcnt vmcnt(6)
    v_mfma_f32_32x32x16_bf16 v[136:151], v[124:127], v[36:39], v[136:151]
    s_waitcnt vmcnt(5)
    v_mfma_f32_32x32x16_bf16 v[136:151], v[128:131], v[44:47], v[136:151]
    s_waitcnt vmcnt(4)
    v_mfma_f32_32x32x16_bf16 v[136:151], v[132:135], v[52:55], v[136:151]
    s_waitcnt vmcnt(3)
    v_mfma_f32_32x32x16_bf16 v[136:151], v[72:75], v[60:63], v[136:151]
    s_waitcnt vmcnt(2)
    v_mfma_f32_32x32x16_bf16 v[136:151], v[76:79], v[68:71], v[136:151]
    s_waitcnt vmcnt(1)
    v_mfma_f32_32x32x16_bf16 v[136:151], v[80:83], v[156:159], v[136:151]
    s_waitcnt vmcnt(0)
    v_mfma_f32_32x32x16_bf16 v[136:151], v[84:87], v[164:167], v[136:151]
    s_nop 11
    v_cvt_pk_bf16_f32 v136, v136, v137
    v_cvt_pk_bf16_f32 v137, v138, v139
    v_cvt_pk_bf16_f32 v138, v140, v141
    v_cvt_pk_bf16_f32 v139, v142, v143
    v_cvt_pk_bf16_f32 v140, v144, v145
    v_cvt_pk_bf16_f32 v141, v146, v147
    v_cvt_pk_bf16_f32 v142, v148, v149
    v_cvt_pk_bf16_f32 v143, v150, v151
    v_permlane32_swap_b32 v136, v138
    v_permlane32_swap_b32 v137, v139
    v_permlane32_swap_b32 v140, v142
    v_permlane32_swap_b32 v141, v143
    buffer_store_dwordx4 v[136:139], v7, s[48:51], s61 offen offset:0
    buffer_store_dwordx4 v[140:143], v7, s[48:51], s61 offen offset:32
    s_branch L_gdone
L_slow:
    s_waitcnt vmcnt(0)
    s_branch L_slowr
L_own:
    ds_read_b32 v19, v16 offset:2300
    s_add_u32 s23, s23, 1
    s_cmp_gt_u32 s23, 131072
    s_cbranch_scc1 L_gdone
    s_sleep 0
L_ownw:
    s_waitcnt lgkmcnt(0)
    v_cmp_ne_u32 vcc, s24, v19
    s_nop 1
    s_cbranch_vccnz L_own
    s_branch L_fin
L_f1t0:
    s_sub_u32 s58, m0, s35
    s_lshl_b32 s58, s58, 3
    s_add_u32 s58, s58, s19
    s_branch L_f1r0
L_f1t1:
    s_cmp_lg_u32 s60, s61
    s_cbranch_scc1 L_f1u
    s_mov_b32 s44, s36
    s_mov_b32 s45, s37
    s_mov_b32 s46, s38
    v_add_u32 v20, 0, v3
    v_add_u32 v21, 7168, v3
    v_add_u32 v22, 14336, v3
    v_add_u32 v23, 21504, v3
L_f1u:
    s_cmp_eq_u32 s60, 14
    s_cselect_b32 s46, 0, s46
    s_sub_u32 s58, m0, s35
    s_lshl_b32 s58, s58, 3
    s_add_u32 s58, s58, s19
    s_branch L_f1r1
L_half:
    s_xor_b32 s59, s54, 1
    s_mul_i32 s59, s59, 12288
    s_add_u32 s59, s59, 65536
    s_waitcnt lgkmcnt(0)
    v_add_u32 v24, s35, v2
    v_add_u32 v25, s59, v2
    v_lshl_add_u32 v26, s55, 2, v1
    v_and_b32 v28, 7, v0
    v_lshlrev_b32 v28, 7, v28
    s_lshl_b32 s59, s4, 10
    s_add_u32 s59, s59, 163840
    s_waitcnt vmcnt(0)
    buffer_load_dwordx2 v[140:141], v28, s[40:43], s59 offen sc1
    s_cmp_eq_u32 s56, 0
    s_cbranch_scc0 L_half1
    ds_write_b128 v24, v[120:123] offset:8192
    ds_write_b128 v24, v[124:127] offset:9216
    ds_write_b128 v24, v[128:131] offset:10240
    ds_write_b128 v24, v[132:135] offset:11264
    s_setprio 0
    v_mfma_f32_32x32x16_bf16 v[104:119], v[8:11], v[12:15], v[104:119]
    s_setprio 3
    v_mov_b32 v27, 1
    s_mov_b64 exec, 1
    ds_add_u32 v26, v27 offset:40
    s_mov_b64 exec, -1
    s_mov_b32 s63, 0
spin_41:
    ds_read_b32 v27, v26 offset:40
    s_add_u32 s63, s63, 1
    s_waitcnt lgkmcnt(0)
    v_readfirstlane_b32 s62, v27
    s_cmp_gt_u32 s63, 131072
    s_cbranch_scc1 spun_42
    s_cmp_lt_u32 s62, 2
    s_cbranch_scc1 spin_41
spun_42:
    ds_read_b128 v[120:123], v25 offset:8192
    ds_read_b128 v[124:127], v25 offset:9216
    ds_read_b128 v[128:131], v25 offset:10240
    ds_read_b128 v[132:135], v25 offset:11264
    s_waitcnt lgkmcnt(0)
    v_mov_b32 v27, 1
    s_mov_b64 exec, 1
    ds_add_u32 v26, v27 offset:40
    s_mov_b64 exec, -1
    v_pk_add_f32 v[104:105], v[104:105], v[120:121]
    v_pk_add_f32 v[106:107], v[106:107], v[122:123]
    v_pk_add_f32 v[108:109], v[108:109], v[124:125]
    v_pk_add_f32 v[110:111], v[110:111], v[126:127]
    v_pk_add_f32 v[112:113], v[112:113], v[128:129]
    v_pk_add_f32 v[114:115], v[114:115], v[130:131]
    v_pk_add_f32 v[116:117], v[116:117], v[132:133]
    v_pk_add_f32 v[118:119], v[118:119], v[134:135]
    s_branch L_epi0
L_half1:
    ds_write_b128 v24, v[104:107] offset:8192
    ds_write_b128 v24, v[108:111] offset:9216
    ds_write_b128 v24, v[112:115] offset:10240
    ds_write_b128 v24, v[116:119] offset:11264
    s_setprio 0
    v_mfma_f32_32x32x16_bf16 v[120:135], v[8:11], v[14:17], v[120:135]
    s_setprio 3
    v_mov_b32 v27, 1
    s_mov_b64 exec, 1
    ds_add_u32 v26, v27 offset:40
    s_mov_b64 exec, -1
    s_mov_b32 s63, 0
spin_43:
    ds_read_b32 v27, v26 offset:40
    s_add_u32 s63, s63, 1
    s_waitcnt lgkmcnt(0)
    v_readfirstlane_b32 s62, v27
    s_cmp_gt_u32 s63, 131072
    s_cbranch_scc1 spun_44
    s_cmp_lt_u32 s62, 2
    s_cbranch_scc1 spin_43
spun_44:
    ds_read_b128 v[104:107], v25 offset:8192
    ds_read_b128 v[108:111], v25 offset:9216
    ds_read_b128 v[112:115], v25 offset:10240
    ds_read_b128 v[116:119], v25 offset:11264
    s_waitcnt lgkmcnt(0)
    v_mov_b32 v27, 1
    s_mov_b64 exec, 1
    ds_add_u32 v26, v27 offset:40
    s_mov_b64 exec, -1
    v_pk_add_f32 v[120:121], v[120:121], v[104:105]
    v_pk_add_f32 v[122:123], v[122:123], v[106:107]
    v_pk_add_f32 v[124:125], v[124:125], v[108:109]
    v_pk_add_f32 v[126:127], v[126:127], v[110:111]
    v_pk_add_f32 v[128:129], v[128:129], v[112:113]
    v_pk_add_f32 v[130:131], v[130:131], v[114:115]
    v_pk_add_f32 v[132:133], v[132:133], v[116:117]
    v_pk_add_f32 v[134:135], v[134:135], v[118:119]
    s_branch L_epi1
L_trip:
    v_cmp_ne_u32 s[14:15], s24, v19
    s_cmp_lt_u32 s11, s10
    s_cbranch_scc1 L_tripf
L_trip1:
    s_add_u32 s57, s0, 6
    s_cmp_ge_u32 s57, s27
    s_cbranch_scc1 L_tripx
L_trip2:
    s_cmp_lt_u32 s10, 8
    s_cselect_b32 s60, s14, 1
    s_cmp_eq_u32 s20, 1
    s_cselect_b32 s60, s60, 1
    s_cmp_eq_u32 s60, 0
    s_cbranch_scc1 L_fin
L_trip4:
    s_cmp_lt_u32 s11, 8
    s_cselect_b32 s21, 1, 0
    s_cmp_lt_u32 s27, 255
    s_cselect_b32 s21, 1, s21
    s_branch L_tripped
L_trip3:
    s_cmp_eq_u32 s20, 3
    s_cbranch_scc1 L_pre0
    s_branch L_trip4
L_tripf:
    s_lshl_b32 s57, s4, 3
    s_add_u32 s57, s57, s5
    s_lshl_b32 s57, s57, 4
    s_add_u32 s57, s57, s11
    s_lshl_b32 s57, s57, 3
    s_add_u32 s57, s57, 196608
    s_mov_b32 s11, s10
    v_mov_b64 v[20:21], s[52:53]
    s_mov_b64 exec, 1
    s_cmp_eq_u32 s25, 0
    s_cbranch_scc1 far_45
    buffer_store_dwordx2 v[20:21], off, s[40:43], s57
std_46:
    s_mov_b64 exec, -1
    s_branch L_trip1
L_tripx:
    s_cmp_eq_u32 s0, s27
    s_cbranch_scc1 L_tripc
    buffer_load_dwordx2 v[14:15], v12, s[40:43], s9 offen sc1
    s_branch L_trip2
L_tripc:
    v_cmp_ne_u64 vcc, s[52:53], v[14:15]
    s_lshl_b32 s19, s58, 14
    s_lshl_b32 s57, s5, 7
    s_add_u32 s19, s19, s57
    s_lshl_b32 s31, s58, 11
    s_add_u32 s31, s31, s8
    s_mov_b32 s27, 255
    s_cbranch_vccz L_trip2
    s_mov_b32 s63, 0
poll_47:
    buffer_load_dwordx2 v[14:15], v12, s[40:43], s9 offen sc1
poll_47w:
    s_add_u32 s63, s63, 1
    s_waitcnt vmcnt(0)
    v_cmp_ne_u64 vcc, s[52:53], v[14:15]
    s_cmp_gt_u32 s63, 131072
    s_cbranch_scc1 polled_48
    s_cbranch_vccz polled_48
    s_sleep 2
    s_branch poll_47
polled_48:
    s_branch L_trip2
L_fin:
    ds_read_b32 v20, v18 offset:2048
    ds_read_b32 v21, v18 offset:4352
    ds_read_b32 v23, v18 offset:6656
    ds_read_b32 v19, v18 offset:8960
    ds_read_b128 v[80:83], v17 offset:0
    ds_read_b128 v[84:87], v17 offset:1024
    ds_read_b128 v[72:75], v17 offset:2304
    ds_read_b128 v[76:79], v17 offset:3328
    s_mov_b32 s60, 0
    s_cmp_eq_u32 s20, 0
    s_cbranch_scc1 L_finw
    s_waitcnt lgkmcnt(0)
    v_pk_add_f32 v[80:81], v[80:81], v[72:73]
    v_pk_add_f32 v[82:83], v[82:83], v[74:75]
    v_pk_add_f32 v[84:85], v[84:85], v[76:77]
    v_pk_add_f32 v[86:87], v[86:87], v[78:79]
    ds_read_b128 v[72:75], v17 offset:4608
    ds_read_b128 v[76:79], v17 offset:5632
    v_add_f32 v20, v20, v21
    v_add_f32 v23, v23, v19
    s_waitcnt lgkmcnt(0)
    v_pk_add_f32 v[80:81], v[80:81], v[72:73]
    v_pk_add_f32 v[82:83], v[82:83], v[74:75]
    v_pk_add_f32 v[84:85], v[84:85], v[76:77]
    v_pk_add_f32 v[86:87], v[86:87], v[78:79]
    ds_read_b128 v[72:75], v17 offset:6912
    ds_read_b128 v[76:79], v17 offset:7936
    s_waitcnt lgkmcnt(0)
    v_pk_add_f32 v[80:81], v[80:81], v[72:73]
    v_pk_add_f32 v[82:83], v[82:83], v[74:75]
    v_pk_add_f32 v[84:85], v[84:85], v[76:77]
    v_pk_add_f32 v[86:87], v[86:87], v[78:79]
    s_and_b32 s57, s10, 1
    s_lshl_b32 s62, s4, 1
    s_add_u32 s57, s57, s62
    s_lshl_b32 s57, s57, 3
    s_add_u32 s57, s57, s5
    s_lshl_b32 s57, s57, 2
    s_lshr_b32 s62, s10, 1
    s_add_u32 s57, s57, s62
    s_lshl_b32 s57, s57, 10
    s_add_u32 s57, s57, 262144
    s_branch L_fin1
L_finw:
    ds_read_b128 v[24:27], v17 offset:4608
    ds_read_b128 v[28:31], v17 offset:5632
    ds_read_b128 v[32:35], v17 offset:6912
    ds_read_b128 v[36:39], v17 offset:7936
    s_and_b32 s57, s10, 1
    s_lshl_b32 s62, s4, 1
    s_add_u32 s57, s57, s62
    s_lshl_b32 s57, s57, 3
    s_add_u32 s57, s57, s5
    s_lshl_b32 s57, s57, 2
    s_lshr_b32 s62, s10, 1
    s_add_u32 s57, s57, s62
    s_lshl_b32 s57, s57, 10
    s_add_u32 s57, s57, 262144
    s_waitcnt lgkmcnt(4)
    v_add_f32 v20, v20, v21
    v_add_f32 v23, v23, v19
    v_pk_add_f32 v[80:81], v[80:81], v[72:73]
    v_pk_add_f32 v[82:83], v[82:83], v[74:75]
    v_pk_add_f32 v[84:85], v[84:85], v[76:77]
    v_pk_add_f32 v[86:87], v[86:87], v[78:79]
    s_waitcnt lgkmcnt(0)
    v_pk_add_f32 v[80:81], v[80:81], v[24:25]
    v_pk_add_f32 v[82:83], v[82:83], v[26:27]
    v_pk_add_f32 v[84:85], v[84:85], v[28:29]
    v_pk_add_f32 v[86:87], v[86:87], v[30:31]
    v_pk_add_f32 v[80:81], v[80:81], v[32:33]
    v_pk_add_f32 v[82:83], v[82:83], v[34:35]
    v_pk_add_f32 v[84:85], v[84:85], v[36:37]
    v_pk_add_f32 v[86:87], v[86:87], v[38:39]
L_fin1:
    v_add_f32 v72, v20, v23
L_fin2:
    v_rcp_f32 v74, v72
    s_mov_b32 s62, 0x76800000
    v_pk_mul_f32 v[80:81], v[80:81], v[74:75] op_sel_hi:[1,0]
    v_pk_mul_f32 v[82:83], v[82:83], v[74:75] op_sel_hi:[1,0]
    v_pk_mul_f32 v[84:85], v[84:85], v[74:75] op_sel_hi:[1,0]
    v_pk_mul_f32 v[86:87], v[86:87], v[74:75] op_sel_hi:[1,0]
    v_cvt_pk_bf16_f32 v76, v80, v81
    v_cvt_pk_bf16_f32 v77, v82, v83
    v_cvt_pk_bf16_f32 v78, v84, v85
    v_cvt_pk_bf16_f32 v79, v86, v87
    s_cmp_eq_u32 s30, 0
    s_cbranch_scc1 far_49
    buffer_store_dwordx4 v[76:79], v2, s[40:43], s57 offen
std_50:
    v_cmp_nle_f32 vcc, 0xb800000, v72
    v_cmp_nge_f32 s[14:15], s62, v72
    v_pk_mul_f32 v[74:75], v[80:81], 0
    v_pk_fma_f32 v[74:75], v[82:83], 0, v[74:75]
    v_pk_fma_f32 v[74:75], v[84:85], 0, v[74:75]
    v_pk_fma_f32 v[74:75], v[86:87], 0, v[74:75]
    s_or_b64 s[14:15], s[14:15], vcc
    v_cmp_u_f32 vcc, v74, v75
    s_nop 1
    s_or_b64 s[14:15], s[14:15], vcc
    s_cselect_b32 s62, 1, 0
    s_cmp_gt_u32 s62, s60
    s_cbranch_scc1 L_fallback
    s_add_u32 s10, s10, 8
    v_mov_b32 v20, s52
    ds_write_b32 v16, v20 offset:2300
    s_cmp_eq_u32 s20, 0
    s_cbranch_scc1 L_ev
    s_branch L_trip3
L_gdone:
L_end:
    s_endpgm
far_29:
    buffer_store_dwordx2 v[136:137], off, s[40:43], s59 sc1
    s_branch std_30
far_35:
    buffer_store_dwordx2 v[20:21], off, s[40:43], s57 sc1
    s_branch std_36
far_39:
    buffer_store_dwordx2 v[14:15], off, s[40:43], s57 sc1
    s_branch std_40
far_45:
    buffer_store_dwordx2 v[20:21], off, s[40:43], s57 sc1
    s_branch std_46
far_49:
    buffer_store_dwordx4 v[76:79], v2, s[40:43], s57 offen sc1
    s_branch std_50
L_fallback:
    s_cmp_eq_u32 s20, 0
    s_cbranch_scc1 L_fbgo
    s_max_u32 s20, s20, 2
    s_branch L_trip3
L_fbgo:
    s_mul_i32 s57, s10, 1536
    s_add_u32 s57, s57, 151552
    v_add_u32 v120, s57, v2
    ds_read_b128 v[24:27], v120
    v_mov_b32 v122, 0xff800000
    s_mov_b32 s57, 0
L_fb1:
    buffer_load_dwordx4 v[28:31], v2, s[40:43], s57 offen sc1
    s_waitcnt vmcnt(0) lgkmcnt(0)
    v_mfma_f32_32x32x16_bf16 v[40:55], v[28:31], v[24:27], 0
    s_nop 11
    v_max3_f32 v123, v40, v41, v42
    v_max3_f32 v123, v123, v43, v44
    v_max3_f32 v123, v123, v45, v46
    v_max3_f32 v123, v123, v47, v48
    v_max3_f32 v123, v123, v49, v50
    v_max3_f32 v123, v123, v51, v52
    v_max3_f32 v123, v123, v53, v54
    v_max_f32 v123, v123, v55
    v_max_f32 v122, v122, v123
    s_add_u32 s57, s57, 1024
    s_cmp_lt_u32 s57, 0x10000
    s_cbranch_scc1 L_fb1
    v_mov_b32 v123, v122
    s_nop 1
    v_permlane32_swap_b32 v122, v123
    v_max_f32 v122, v122, v123
    v_sub_f32 v56, 0, v122
    v_mov_b32 v72, 0
    v_sub_f32 v57, 0, v122
    v_mov_b32 v73, 0
    v_sub_f32 v58, 0, v122
    v_mov_b32 v74, 0
    v_sub_f32 v59, 0, v122
    v_mov_b32 v75, 0
    v_sub_f32 v60, 0, v122
    v_mov_b32 v76, 0
    v_sub_f32 v61, 0, v122
    v_mov_b32 v77, 0
    v_sub_f32 v62, 0, v122
    v_mov_b32 v78, 0
    v_sub_f32 v63, 0, v122
    v_mov_b32 v79, 0
    v_sub_f32 v64, 0, v122
    v_mov_b32 v80, 0
    v_sub_f32 v65, 0, v122
    v_mov_b32 v81, 0
    v_sub_f32 v66, 0, v122
    v_mov_b32 v82, 0
    v_sub_f32 v67, 0, v122
    v_mov_b32 v83, 0
    v_sub_f32 v68, 0, v122
    v_mov_b32 v84, 0
    v_sub_f32 v69, 0, v122
    v_mov_b32 v85, 0
    v_sub_f32 v70, 0, v122
    v_mov_b32 v86, 0
    v_sub_f32 v71, 0, v122
    v_mov_b32 v87, 0
    s_mov_b32 s57, 0
L_fb2:
    s_add_u32 s62, s57, 65536
    buffer_load_dwordx4 v[28:31], v2, s[40:43], s57 offen sc1
    buffer_load_dwordx4 v[32:35], v2, s[40:43], s62 offen sc1
    v_mov_b32 v36, 0x3f803f80
    v_mov_b32 v37, 0x3f803f80
    v_mov_b32 v38, 0x3f803f80
    v_mov_b32 v39, 0x3f803f80
    s_waitcnt vmcnt(0)
    v_mfma_f32_32x32x16_bf16 v[40:55], v[28:31], v[24:27], v[56:71]
    v_permlane16_swap_b32 v36, v32
    v_permlane16_swap_b32 v37, v33
    v_permlane16_swap_b32 v38, v34
    v_permlane16_swap_b32 v39, v35
    s_nop 7
    v_exp_f32 v40, v40
    v_exp_f32 v41, v41
    v_exp_f32 v42, v42
    v_exp_f32 v43, v43
    v_exp_f32 v44, v44
    v_exp_f32 v45, v45
    v_exp_f32 v46, v46
    v_exp_f32 v47, v47
    v_exp_f32 v48, v48
    v_exp_f32 v49, v49
    v_exp_f32 v50, v50
    v_exp_f32 v51, v51
    v_exp_f32 v52, v52
    v_exp_f32 v53, v53
    v_exp_f32 v54, v54
    v_exp_f32 v55, v55
    v_mov_b32 v120, 0xdddddddd
    s_nop 1
    v_smfmac_f32_32x32x32_bf16 v[72:87], v[32:35], v[40:47], v120
    v_smfmac_f32_32x32x32_bf16 v[72:87], v[36:39], v[48:55], v120
    s_add_u32 s57, s57, 1024
    s_cmp_lt_u32 s57, 0x10000
    s_cbranch_scc1 L_fb2
    s_nop 15
    s_mov_b32 s60, 1
    s_and_b32 s57, s10, 1
    s_lshl_b32 s62, s4, 1
    s_add_u32 s57, s57, s62
    s_lshl_b32 s57, s57, 3
    s_add_u32 s57, s57, s5
    s_lshl_b32 s57, s57, 2
    s_lshr_b32 s62, s10, 1
    s_add_u32 s57, s57, s62
    s_lshl_b32 s57, s57, 10
    s_add_u32 s57, s57, 262144
    s_branch L_fin2
.section .rodata,"a"
.p2align 6
.amdhsa_kernel parallel_sum__grouped_kv_mqa__dense_activation_squared_relu__prompt_kernel
  .amdhsa_next_free_vgpr 168
  .amdhsa_next_free_sgpr 100
  .amdhsa_accum_offset 168
  .amdhsa_group_segment_fixed_size 0
  .amdhsa_kernarg_size 104
  .amdhsa_user_sgpr_count 2
  .amdhsa_user_sgpr_kernarg_segment_ptr 1
  .amdhsa_system_sgpr_workgroup_id_x 1
.end_amdhsa_kernel
```
